```python
import torch

def _softmax(x, axis=-1):
    return torch.softmax(x, dim=axis)
def _gelu(x):
    return torch.nn.functional.gelu(x, approximate="tanh")
def _silu(x):
    return torch.nn.functional.silu(x)
def _sigmoid(x):
    return torch.sigmoid(x)
def _layernorm(x, axis=-1, eps=1e-5):
    m = x.mean(dim=axis, keepdim=True)
    v = x.var(dim=axis, keepdim=True, unbiased=False)
    return (x - m) / torch.sqrt(v + eps)
def _scatter_add(tgt, idx, src, axis=0):
    return tgt.clone().index_add_(axis, idx, src)
def _segment_sum(src, seg, n):
    out = torch.zeros((n,) + src.shape[1:], dtype=src.dtype)
    return out.index_add_(0, seg, src)
def _pad(x, pw):
    flat = tuple(v for pair in reversed(pw) for v in pair)
    return torch.nn.functional.pad(x, flat)

kernel_name = 'gated_mix__mha_block__glu_gated_geglu__prompt'

def setup_inputs():

    _w = (lambda a: (lambda t: t.to(torch.bfloat16) if t.is_floating_point() else t)(torch.as_tensor(a)))
    def _A_setup():
        B, S, D, H = 1, 2048, 512, 32
        return {
            "x": _w((lambda *s: torch.randn(*s, dtype=torch.bfloat16) * 0.05)(B, S, D)),
            "wqkv": _w((lambda *s: torch.randn(*s, dtype=torch.bfloat16) * 0.8)(D, 3 * D)),
            "wo": _w((lambda *s: torch.randn(*s, dtype=torch.bfloat16) * 0.05)(D, D)),
        }
    _A_in = _A_setup()

    def _B_setup():
        B, S, Dm, Df = 1, 2048, 512, 1792
        return {
            "x": _w((lambda *s: torch.randn(*s, dtype=torch.bfloat16) * 0.05)(B, S, Dm)),
            "w_gate": _w((lambda *s: torch.randn(*s, dtype=torch.bfloat16) * 3.2)(Dm, Df) * (Dm ** -0.5)),
            "w_up": _w((lambda *s: torch.randn(*s, dtype=torch.bfloat16) * 3.2)(Dm, Df) * (Dm ** -0.5)),
            "w_down": _w((lambda *s: torch.randn(*s, dtype=torch.bfloat16) * 3.2)(Df, Dm) * (Df ** -0.5)),
        }
    _B_in = _B_setup()

    return {
        "A_x": _A_in["x"],
        "A_wqkv": _A_in["wqkv"],
        "A_wo": _A_in["wo"],
        "B_x": _B_in["x"],
        "B_w_gate": _B_in["w_gate"],
        "B_w_up": _B_in["w_up"],
        "B_w_down": _B_in["w_down"],
        "gate_w": _w((lambda *s: torch.randn(*s, dtype=torch.bfloat16) * 0.05)(512) * 16.0),
    }

def reference(A_x, A_wqkv, A_wo, B_x, B_w_gate, B_w_up, B_w_down, gate_w):
    def _A_ref(x, wqkv, wo):
        B, S, D = x.shape
        H = 32
        Dh = D // H
        qkv = (lambda x, *d: x.permute(*d))((x @ wqkv).reshape(B, S, 3, H, Dh), 2, 0, 3, 1, 4)
        q, k, v = qkv[0], qkv[1], qkv[2]
        scores = torch.einsum("bhqd,bhkd->bhqk", q, k) * (Dh ** -0.5)
        p = _softmax(scores, axis=-1)
        o = torch.einsum("bhqk,bhkd->bhqd", p, v)
        return (lambda x, *d: x.permute(*d))(o, 0, 2, 1, 3).reshape(B, S, D) @ wo

    def _B_ref(x, w_gate, w_up, w_down):
        g = torch.einsum("bsd,df->bsf", x, w_gate)
        u = torch.einsum("bsd,df->bsf", x, w_up)
        h = _gelu(g) * u
        return torch.einsum("bsf,fd->bsd", h, w_down)

    x = A_x
    g = _sigmoid((x * gate_w).sum(-1, keepdims=True))
    a = _A_ref(x, A_wqkv, A_wo)
    b = _B_ref(x, B_w_gate, B_w_up, B_w_down)
    return g * a + (1 - g) * b
```

```asm
; @launch grid=(256,1,1) block=(512,1,1) lds=163840
.amdgcn_target "amdgcn-amd-amdhsa--gfx950"
.text
.globl gated_mix__mha_block__glu_gated_geglu__prompt_kernel
.p2align 8
.type gated_mix__mha_block__glu_gated_geglu__prompt_kernel,@function
gated_mix__mha_block__glu_gated_geglu__prompt_kernel:
    s_cmp_ge_u32 s2, 256
    s_cbranch_scc1 L_end
    s_load_dwordx2 s[28:29], s[0:1], 0
    s_load_dwordx2 s[40:41], s[0:1], 8
    s_load_dwordx2 s[32:33], s[0:1], 32
    s_load_dwordx2 s[36:37], s[0:1], 40
    s_load_dwordx2 s[48:49], s[0:1], 56
    s_load_dwordx2 s[44:45], s[0:1], 80
    v_lshrrev_b32 v3, 6, v0
    v_and_b32 v1, 63, v0
    v_readfirstlane_b32 s52, v3
    v_lshlrev_b32 v2, 4, v1
    s_getpc_b64 s[26:27]
L_pc:
    s_lshr_b32 s53, s2, 3
    s_mul_i32 s53, s53, 10
    v_min_u32 v3, 9, v1
    v_add_lshl_u32 v3, v3, s53, 7
    v_min_u32 v3, L_end-L_pc, v3
    global_load_dword v12, v3, s[26:27]
    s_and_b32 s53, s2, 1
    s_lshl_b32 s53, s53, 3
    s_bfe_u32 s55, s2, 196611
    s_add_u32 s60, s53, s55
    s_bfe_u32 s53, s2, 131073
    s_lshr_b32 s54, s2, 6
    s_lshl2_add_u32 s61, s54, s53
    s_add_u32 s56, s54, s55
    s_and_b32 s3, s52, 3
    s_lshr_b32 s63, s52, 2
    s_lshl_b32 s57, s52, 10
    v_lshrrev_b32 v3, 3, v0
    v_and_b32 v4, 7, v1
    v_lshrrev_b32 v5, 2, v1
    v_and_b32 v5, 4, v5
    v_xor_b32 v5, v4, v5
    v_lshlrev_b32 v5, 4, v5
    v_bfe_u32 v6, v3, 1, 3
    v_xor_b32 v6, v4, v6
    v_lshlrev_b32 v6, 4, v6
    v_lshl_add_u32 v13, v3, 10, v6
    v_mul_u32_u24 v14, 3072, v3
    v_add_u32 v14, v14, v5
    v_mul_u32_u24 v15, 3584, v3
    v_add_u32 v15, v15, v5
    s_lshl_b32 s65, s60, 17
    s_lshl2_add_u32 s64, s60, s3
    s_mov_b32 s30, 2097152
    s_mov_b32 s31, 0x20000
    s_mov_b32 s42, 1572864
    s_mov_b32 s43, 0x20000
    s_mov_b32 s34, 1835008
    s_mov_b32 s35, 0x20000
    s_mov_b32 s38, 1835008
    s_mov_b32 s39, 0x20000
    s_mov_b32 s50, 1024
    s_mov_b32 s51, 0x20000
    s_mov_b32 s46, 17825792
    s_mov_b32 s47, 0x20000
    s_lshl_b32 s53, s56, 7
    s_and_b32 s4, s53, 0x1ff
    s_add_u32 s53, s53, 64
    s_and_b32 s5, s53, 0x1ff
    s_add_u32 s53, s53, 64
    s_and_b32 s6, s53, 0x1ff
    s_add_u32 s53, s53, 64
    s_and_b32 s7, s53, 0x1ff
    s_add_u32 s53, s53, 64
    s_and_b32 s12, s53, 0x1ff
    s_add_u32 s53, s53, 64
    s_and_b32 s13, s53, 0x1ff
    s_add_u32 s53, s53, 64
    s_and_b32 s14, s53, 0x1ff
    s_add_u32 s53, s53, 64
    s_and_b32 s15, s53, 0x1ff
    s_cmp_ge_u32 s61, 12
    s_cbranch_scc1 L_p1B
    s_lshl_b32 s66, s61, 7
    s_mov_b32 s67, s66
    s_mov_b32 s68, s67
    s_add_u32 s69, s67, 1536
    s_mov_b32 s70, s69
    s_lshl1_add_u32 s80, s4, s65
    s_add_u32 s80, s80, 0
    s_lshl1_add_u32 s81, s4, s65
    s_add_u32 s81, s81, 65536
    s_mul_i32 s82, s4, 3072
    s_add_u32 s82, s82, s66
    s_mul_i32 s83, s4, 3584
    s_add_u32 s83, s83, s67
    s_mul_i32 s84, s4, 3584
    s_add_u32 s84, s84, s68
    s_waitcnt lgkmcnt(0)
    s_load_dwordx2 s[8:9], s[0:1], 16
    s_load_dwordx2 s[16:17], s[0:1], 48
    s_load_dwordx2 s[24:25], s[0:1], 80
    s_load_dwordx4 s[20:23], s[0:1], 64
    s_add_u32 m0, s57, 0
    s_nop 0
    buffer_load_dwordx4 v13, s[28:31], s80 offen lds
    s_add_u32 m0, s57, 8192
    s_nop 0
    buffer_load_dwordx4 v13, s[28:31], s81 offen lds
    s_add_u32 m0, s57, 65536
    s_nop 0
    buffer_load_dwordx4 v14, s[40:43], s82 offen lds
    s_add_u32 m0, s57, 73728
    s_nop 0
    buffer_load_dwordx4 v15, s[32:35], s83 offen lds
    s_add_u32 m0, s57, 81920
    s_nop 0
    buffer_load_dwordx4 v15, s[36:39], s84 offen lds
    buffer_load_dwordx4 v[44:47], v2, s[48:51], 0 offen
    s_waitcnt lgkmcnt(0)
    s_mov_b32 s48, s22
    s_and_b32 s49, s23, 0xffff
    s_mov_b32 s50, 256
    s_mov_b32 s51, 0x20000
    s_memrealtime s[26:27]
    s_or_b32 s53, s2, s52
    s_cmp_eq_u32 s53, 0
    s_cselect_b32 s53, 0, 256
    s_waitcnt lgkmcnt(0)
    v_mov_b32 v4, s26
    v_mov_b32 v5, s27
    v_or_b32 v4, 1, v4
    v_mov_b32 v3, 0
    s_mov_b64 exec, 1
    buffer_store_dwordx2 v[4:5], v3, s[48:51], s53 offen sc1
    s_mov_b64 exec, -1
    v_and_b32 v7, 31, v1
    v_lshrrev_b32 v8, 5, v1
    v_bfe_u32 v9, v1, 1, 3
    v_xor_b32 v9, v9, v8
    v_lshlrev_b32 v9, 4, v9
    s_lshl_b32 s53, s3, 5
    v_add_u32 v7, s53, v7
    v_lshl_add_u32 v16, v7, 7, v9
    v_xor_b32 v17, 32, v16
    v_xor_b32 v18, 64, v16
    v_xor_b32 v19, 96, v16
    v_lshlrev_b32 v9, 10, v8
    v_bfe_u32 v6, v1, 2, 2
    v_lshl_add_u32 v9, v6, 7, v9
    v_bfe_u32 v6, v1, 3, 1
    v_xor_b32 v6, s63, v6
    v_lshl_add_u32 v9, v6, 6, v9
    v_bfe_u32 v6, v1, 4, 1
    v_lshl_add_u32 v9, v6, 5, v9
    v_and_b32 v6, 3, v1
    v_lshl_add_u32 v20, v6, 3, v9
    v_add_u32 v21, 65536, v20
    v_add_u32 v22, 131072, v20
    v_mov_b32 v248, 0xc0135761
    v_mov_b32 v249, 0xc0135761
    v_mov_b32 v254, 0xdddddddd
    s_lshl1_add_u32 s53, s61, s63
    s_lshl_b32 s71, s53, 7
    s_add_u32 s71, s71, s64
    s_lshl_b32 s71, s71, 10
    s_lshl4_add_u32 s94, s61, s60
    s_lshl_b32 s94, s94, 7
    s_add_u32 s94, s94, 16842752
    s_cmp_eq_u32 s52, 0
    s_cselect_b32 s94, s94, 17825792
    s_lshl_b32 s90, s64, 5
    s_add_u32 s90, s90, s53
    s_lshl_b32 s90, s90, 7
    s_add_u32 s90, s90, 16908288
    s_lshl4_add_u32 s54, s60, s61
    s_lshl3_add_u32 s79, s54, s52
    s_lshl_b32 s79, s79, 10
    s_lshl_b32 s78, s54, 7
    s_lshl2_add_u32 s78, s52, s78
    s_add_u32 s78, s78, 16777216
    s_mul_i32 s54, s64, 144
    s_add_u32 s95, s54, s53
    s_lshl_b32 s95, s95, 10
    s_add_u32 s95, s95, 6291456
    s_lshl1_add_u32 s54, s63, s54
    s_lshr_b32 s76, s67, 5
    s_add_u32 s76, s76, s54
    s_lshl_b32 s76, s76, 10
    s_add_u32 s76, s76, 6324224
    s_lshr_b32 s77, s69, 5
    s_add_u32 s77, s77, s54
    s_lshl_b32 s77, s77, 10
    s_add_u32 s77, s77, 6324224
    s_cmp_lt_u32 s61, 8
    s_cselect_b32 s72, 0x3eb8aa3b, 1.0
    s_mov_b32 s74, 0xbdd2d3e8
    s_mov_b32 s75, s74
    s_and_b32 s53, s2, 7
    s_bfe_u32 s54, s2, 131075
    s_lshl2_add_u32 s80, s53, s54
    s_lshl_b32 s82, s80, 1
    s_lshr_b32 s83, s2, 5
    s_lshl1_add_u32 s81, s3, s63
    s_lshl3_add_u32 s81, s83, s81
    s_lshl_b32 s53, s80, 16
    s_add_u32 s88, s53, s57
    s_add_u32 s88, s88, 2097152
    s_lshl_b32 s101, s81, 10
    s_add_u32 s101, s101, s53
    s_mul_i32 s97, s81, 144
    s_add_u32 s97, s97, s80
    s_lshl_b32 s97, s97, 10
    s_add_u32 s97, s97, 6291456
    s_lshl_b32 s99, s81, 9
    s_add_u32 s99, s99, 16777216
    s_add_u32 s54, s82, s63
    s_lshl_b32 s100, s54, 9
    s_add_u32 s100, s100, 16777216
    s_lshl_b32 s96, s54, 15
    s_lshl_b32 s55, s83, 7
    s_add_u32 s96, s96, s55
    s_lshl_b32 s55, s3, 5
    s_add_u32 s96, s96, s55
    s_mul_i32 s86, s54, 144
    s_lshl3_add_u32 s98, s3, s86
    s_lshl_b32 s98, s98, 10
    s_add_u32 s98, s98, 6291456
    s_xor_b32 s54, s54, 1
    s_mul_i32 s87, s54, 144
    s_mul_i32 s55, s52, 14
    s_add_u32 s55, s55, 6176
    s_add_u32 s86, s86, s55
    s_add_u32 s87, s87, s55
    s_lshl_b32 s86, s86, 10
    s_lshl_b32 s87, s87, 10
    s_mul_i32 s85, s52, 229376
    s_lshl_b32 s84, s52, 12
    s_add_u32 s84, s84, 131072
    s_lshr_b32 s53, s52, 1
    s_lshl_b32 s53, s53, 15
    s_and_b32 s91, s52, 1
    s_lshl_b32 s91, s91, 13
    s_add_u32 s91, s91, s53
    s_mul_i32 s62, s63, 6144
    s_lshl_b32 s53, s3, 15
    s_add_u32 s62, s62, s53
    s_add_u32 s62, s62, 16384
    s_lshl_b32 s89, s63, 15
    s_mov_b32 s92, 0xffff
    s_mov_b32 s93, 0xffff
    v_and_b32 v6, 15, v1
    s_lshr_b32 s53, s80, 2
    s_lshl_b32 s53, s53, 4
    s_add_u32 s54, s53, 128
    v_add_u32 v7, s54, v6
    s_lshr_b32 s54, s80, 3
    s_lshl_b32 s54, s54, 4
    s_add_u32 s54, s54, 192
    v_add_u32 v8, s54, v6
    v_cmp_lt_u32 vcc, 15, v1
    s_nop 1
    v_cndmask_b32 v7, v7, v8, vcc
    s_lshl1_add_u32 s53, s83, s53
    v_and_b32 v6, 1, v1
    v_add_u32 v8, s53, v6
    v_cmp_lt_u32 vcc, 31, v1
    s_nop 1
    v_cndmask_b32 v7, v7, v8, vcc
    v_lshlrev_b32 v7, 7, v7
    v_add_u32 v252, 16842752, v7
    v_and_b32 v6, 7, v1
    v_min_u32 v7, 6, v6
    s_mul_i32 s53, s52, 7
    v_add_u32 v7, s53, v7
    v_subrev_u32 v9, 24, v7
    v_cmp_lt_u32 vcc, 23, v7
    s_nop 1
    v_cndmask_b32 v7, v7, v9, vcc
    v_bfe_u32 v8, v1, 3, 1
    v_add_u32 v8, s82, v8
    v_lshl_add_u32 v7, v8, 5, v7
    s_add_u32 s55, s82, s63
    s_lshl_b32 s53, s55, 5
    s_lshl3_add_u32 s53, s3, s53
    v_add_u32 v8, s53, v6
    v_cmp_lt_u32 vcc, 15, v1
    s_nop 1
    v_cndmask_b32 v7, v7, v8, vcc
    v_add_u32 v7, 512, v7
    v_and_b32 v6, 3, v1
    v_lshlrev_b32 v6, 4, v6
    s_and_b32 s53, s81, 3
    s_lshl_b32 s53, s53, 6
    s_lshr_b32 s54, s81, 2
    s_add_u32 s53, s53, s54
    v_add_u32 v8, s53, v6
    v_cmp_lt_u32 vcc, 23, v1
    s_nop 1
    v_cndmask_b32 v7, v7, v8, vcc
    s_and_b32 s53, s55, 3
    s_lshl_b32 s53, s53, 6
    s_lshr_b32 s54, s55, 2
    s_add_u32 s53, s53, s54
    v_add_u32 v8, s53, v6
    v_cmp_lt_u32 vcc, 27, v1
    s_nop 1
    v_cndmask_b32 v7, v7, v8, vcc
    s_lshl_b32 s53, s81, 5
    s_add_u32 s53, s53, s80
    s_add_u32 s53, s53, 512
    v_mov_b32 v8, s53
    v_cmp_lt_u32 vcc, 31, v1
    s_nop 1
    v_cndmask_b32 v7, v7, v8, vcc
    v_lshlrev_b32 v7, 7, v7
    v_add_u32 v253, 16842752, v7
    s_lshl1_add_u32 s53, s5, s65
    s_add_u32 m0, s57, 16384
    s_add_u32 s53, s53, 0
    buffer_load_dwordx4 v13, s[28:31], s53 offen lds
    s_lshl1_add_u32 s53, s5, s65
    s_add_u32 m0, s57, 24576
    s_add_u32 s53, s53, 65536
    buffer_load_dwordx4 v13, s[28:31], s53 offen lds
    s_mul_i32 s53, s5, 3072
    s_add_u32 m0, s57, 90112
    s_add_u32 s53, s53, s66
    buffer_load_dwordx4 v14, s[40:43], s53 offen lds
    s_mul_i32 s53, s5, 3584
    s_add_u32 m0, s57, 98304
    s_add_u32 s53, s53, s67
    buffer_load_dwordx4 v15, s[32:35], s53 offen lds
    s_mul_i32 s53, s5, 3584
    s_add_u32 m0, s57, 106496
    s_add_u32 s53, s53, s68
    buffer_load_dwordx4 v15, s[36:39], s53 offen lds
    s_waitcnt vmcnt(7)
    s_barrier
    ds_read_b64_tr_b16 v[24:25], v21 offset:0
    ds_read_b64_tr_b16 v[26:27], v21 offset:512
    ds_read_b128 v[120:123], v16 offset:0
    ds_read_b64_tr_b16 v[28:29], v21 offset:2048
    ds_read_b64_tr_b16 v[30:31], v21 offset:2560
    ds_read_b128 v[124:127], v17 offset:0
    ds_read_b64_tr_b16 v[32:33], v21 offset:4096
    ds_read_b64_tr_b16 v[34:35], v21 offset:4608
    ds_read_b128 v[128:131], v18 offset:0
    ds_read_b64_tr_b16 v[36:37], v21 offset:6144
    ds_read_b64_tr_b16 v[38:39], v21 offset:6656
    ds_read_b128 v[132:135], v19 offset:0
    s_waitcnt lgkmcnt(9)
    v_mfma_f32_32x32x16_bf16 v[56:71], v[24:27], v[120:123], 0
    ds_read_b64_tr_b16 v[24:25], v21 offset:8192
    ds_read_b64_tr_b16 v[26:27], v21 offset:8704
    s_lshl1_add_u32 s53, s6, s65
    s_add_u32 m0, s57, 32768
    s_add_u32 s53, s53, 0
    buffer_load_dwordx4 v13, s[28:31], s53 offen lds
    s_waitcnt lgkmcnt(8)
    v_mfma_f32_32x32x16_bf16 v[56:71], v[28:31], v[124:127], v[56:71]
    ds_read_b64_tr_b16 v[28:29], v21 offset:10240
    ds_read_b64_tr_b16 v[30:31], v21 offset:10752
    s_waitcnt lgkmcnt(7)
    v_mfma_f32_32x32x16_bf16 v[56:71], v[32:35], v[128:131], v[56:71]
    ds_read_b64_tr_b16 v[32:33], v21 offset:12288
    ds_read_b64_tr_b16 v[34:35], v21 offset:12800
    s_lshl1_add_u32 s53, s6, s65
    s_add_u32 m0, s57, 40960
    s_add_u32 s53, s53, 65536
    buffer_load_dwordx4 v13, s[28:31], s53 offen lds
    s_waitcnt lgkmcnt(6)
    v_mfma_f32_32x32x16_bf16 v[56:71], v[36:39], v[132:135], v[56:71]
    ds_read_b64_tr_b16 v[36:37], v21 offset:14336
    ds_read_b64_tr_b16 v[38:39], v21 offset:14848
    s_waitcnt lgkmcnt(6)
    v_mfma_f32_32x32x16_bf16 v[72:87], v[24:27], v[120:123], 0
    ds_read_b64_tr_b16 v[24:25], v21 offset:16384
    ds_read_b64_tr_b16 v[26:27], v21 offset:16896
    s_mul_i32 s53, s6, 3072
    s_add_u32 m0, s57, 114688
    s_add_u32 s53, s53, s66
    buffer_load_dwordx4 v14, s[40:43], s53 offen lds
    s_waitcnt lgkmcnt(6)
    v_mfma_f32_32x32x16_bf16 v[72:87], v[28:31], v[124:127], v[72:87]
    ds_read_b64_tr_b16 v[28:29], v21 offset:18432
    ds_read_b64_tr_b16 v[30:31], v21 offset:18944
    s_waitcnt lgkmcnt(6)
    v_mfma_f32_32x32x16_bf16 v[72:87], v[32:35], v[128:131], v[72:87]
    ds_read_b64_tr_b16 v[32:33], v21 offset:20480
    ds_read_b64_tr_b16 v[34:35], v21 offset:20992
    s_mul_i32 s53, s6, 3584
    s_add_u32 m0, s57, 122880
    s_add_u32 s53, s53, s67
    buffer_load_dwordx4 v15, s[32:35], s53 offen lds
    s_waitcnt lgkmcnt(6)
    v_mfma_f32_32x32x16_bf16 v[72:87], v[36:39], v[132:135], v[72:87]
    ds_read_b64_tr_b16 v[36:37], v21 offset:22528
    ds_read_b64_tr_b16 v[38:39], v21 offset:23040
    s_waitcnt lgkmcnt(6)
    v_mfma_f32_32x32x16_bf16 v[88:103], v[24:27], v[120:123], 0
    s_mul_i32 s53, s6, 3584
    s_add_u32 m0, s57, 131072
    s_add_u32 s53, s53, s68
    buffer_load_dwordx4 v15, s[36:39], s53 offen lds
    s_waitcnt lgkmcnt(4)
    v_mfma_f32_32x32x16_bf16 v[88:103], v[28:31], v[124:127], v[88:103]
    s_waitcnt lgkmcnt(2)
    v_mfma_f32_32x32x16_bf16 v[88:103], v[32:35], v[128:131], v[88:103]
    s_lshl1_add_u32 s53, s7, s65
    s_add_u32 m0, s57, 49152
    s_add_u32 s53, s53, 0
    buffer_load_dwordx4 v13, s[28:31], s53 offen lds
    s_waitcnt lgkmcnt(0)
    s_waitcnt vmcnt(3)
    v_mfma_f32_32x32x16_bf16 v[88:103], v[36:39], v[132:135], v[88:103]
    s_barrier
    ds_read_b64_tr_b16 v[24:25], v21 offset:24576
    ds_read_b64_tr_b16 v[26:27], v21 offset:25088
    ds_read_b128 v[136:139], v16 offset:16384
    ds_read_b64_tr_b16 v[28:29], v21 offset:26624
    ds_read_b64_tr_b16 v[30:31], v21 offset:27136
    ds_read_b128 v[140:143], v17 offset:16384
    ds_read_b64_tr_b16 v[32:33], v21 offset:28672
    ds_read_b64_tr_b16 v[34:35], v21 offset:29184
    ds_read_b128 v[144:147], v18 offset:16384
    ds_read_b64_tr_b16 v[36:37], v21 offset:30720
    ds_read_b64_tr_b16 v[38:39], v21 offset:31232
    ds_read_b128 v[148:151], v19 offset:16384
    s_waitcnt lgkmcnt(9)
    v_mfma_f32_32x32x16_bf16 v[56:71], v[24:27], v[136:139], v[56:71]
    ds_read_b64_tr_b16 v[24:25], v21 offset:32768
    ds_read_b64_tr_b16 v[26:27], v21 offset:33280
    s_lshl1_add_u32 s53, s7, s65
    s_add_u32 m0, s57, 57344
    s_add_u32 s53, s53, 65536
    buffer_load_dwordx4 v13, s[28:31], s53 offen lds
    s_waitcnt lgkmcnt(8)
    v_mfma_f32_32x32x16_bf16 v[56:71], v[28:31], v[140:143], v[56:71]
    ds_read_b64_tr_b16 v[28:29], v21 offset:34816
    ds_read_b64_tr_b16 v[30:31], v21 offset:35328
    s_waitcnt lgkmcnt(7)
    v_mfma_f32_32x32x16_bf16 v[56:71], v[32:35], v[144:147], v[56:71]
    ds_read_b64_tr_b16 v[32:33], v21 offset:36864
    ds_read_b64_tr_b16 v[34:35], v21 offset:37376
    s_mul_i32 s53, s7, 3072
    s_add_u32 m0, s57, 139264
    s_add_u32 s53, s53, s66
    buffer_load_dwordx4 v14, s[40:43], s53 offen lds
    s_waitcnt lgkmcnt(6)
    v_mfma_f32_32x32x16_bf16 v[56:71], v[36:39], v[148:151], v[56:71]
    ds_read_b64_tr_b16 v[36:37], v21 offset:38912
    ds_read_b64_tr_b16 v[38:39], v21 offset:39424
    s_waitcnt lgkmcnt(6)
    v_mfma_f32_32x32x16_bf16 v[72:87], v[24:27], v[136:139], v[72:87]
    ds_read_b64_tr_b16 v[24:25], v21 offset:40960
    ds_read_b64_tr_b16 v[26:27], v21 offset:41472
    s_mul_i32 s53, s7, 3584
    s_add_u32 m0, s57, 147456
    s_add_u32 s53, s53, s67
    buffer_load_dwordx4 v15, s[32:35], s53 offen lds
    s_waitcnt lgkmcnt(6)
    v_mfma_f32_32x32x16_bf16 v[72:87], v[28:31], v[140:143], v[72:87]
    ds_read_b64_tr_b16 v[28:29], v21 offset:43008
    ds_read_b64_tr_b16 v[30:31], v21 offset:43520
    s_waitcnt lgkmcnt(6)
    v_mfma_f32_32x32x16_bf16 v[72:87], v[32:35], v[144:147], v[72:87]
    ds_read_b64_tr_b16 v[32:33], v21 offset:45056
    ds_read_b64_tr_b16 v[34:35], v21 offset:45568
    s_mul_i32 s53, s7, 3584
    s_add_u32 m0, s57, 155648
    s_add_u32 s53, s53, s68
    buffer_load_dwordx4 v15, s[36:39], s53 offen lds
    s_waitcnt lgkmcnt(6)
    v_mfma_f32_32x32x16_bf16 v[72:87], v[36:39], v[148:151], v[72:87]
    ds_read_b64_tr_b16 v[36:37], v21 offset:47104
    ds_read_b64_tr_b16 v[38:39], v21 offset:47616
    s_waitcnt lgkmcnt(6)
    v_mfma_f32_32x32x16_bf16 v[88:103], v[24:27], v[136:139], v[88:103]
    ds_read_b64_tr_b16 v[24:25], v21 offset:49152
    ds_read_b64_tr_b16 v[26:27], v21 offset:49664
    ds_read_b128 v[152:155], v16 offset:32768
    s_lshl1_add_u32 s53, s12, s65
    s_add_u32 m0, s57, 0
    s_add_u32 s53, s53, 0
    buffer_load_dwordx4 v13, s[28:31], s53 offen lds
    s_waitcnt lgkmcnt(7)
    v_mfma_f32_32x32x16_bf16 v[88:103], v[28:31], v[140:143], v[88:103]
    ds_read_b64_tr_b16 v[28:29], v21 offset:51200
    ds_read_b64_tr_b16 v[30:31], v21 offset:51712
    ds_read_b128 v[156:159], v17 offset:32768
    s_waitcnt lgkmcnt(8)
    v_mfma_f32_32x32x16_bf16 v[88:103], v[32:35], v[144:147], v[88:103]
    ds_read_b64_tr_b16 v[32:33], v21 offset:53248
    ds_read_b64_tr_b16 v[34:35], v21 offset:53760
    ds_read_b128 v[160:163], v18 offset:32768
    s_lshl1_add_u32 s53, s12, s65
    s_add_u32 m0, s57, 8192
    s_add_u32 s53, s53, 65536
    buffer_load_dwordx4 v13, s[28:31], s53 offen lds
    s_waitcnt lgkmcnt(9)
    s_waitcnt lgkmcnt(6)
    s_waitcnt vmcnt(4)
    v_mfma_f32_32x32x16_bf16 v[88:103], v[36:39], v[148:151], v[88:103]
    s_barrier
    v_mfma_f32_32x32x16_bf16 v[56:71], v[24:27], v[152:155], v[56:71]
    ds_read_b64_tr_b16 v[36:37], v21 offset:55296
    ds_read_b64_tr_b16 v[38:39], v21 offset:55808
    ds_read_b128 v[164:167], v19 offset:32768
    ds_read_b64_tr_b16 v[24:25], v21 offset:57344
    ds_read_b64_tr_b16 v[26:27], v21 offset:57856
    s_mul_i32 s53, s12, 3072
    s_add_u32 m0, s57, 65536
    s_add_u32 s53, s53, s66
    buffer_load_dwordx4 v14, s[40:43], s53 offen lds
    s_waitcnt lgkmcnt(8)
    v_mfma_f32_32x32x16_bf16 v[56:71], v[28:31], v[156:159], v[56:71]
    ds_read_b64_tr_b16 v[28:29], v21 offset:59392
    ds_read_b64_tr_b16 v[30:31], v21 offset:59904
    s_waitcnt lgkmcnt(7)
    v_mfma_f32_32x32x16_bf16 v[56:71], v[32:35], v[160:163], v[56:71]
    ds_read_b64_tr_b16 v[32:33], v21 offset:61440
    ds_read_b64_tr_b16 v[34:35], v21 offset:61952
    s_mul_i32 s53, s12, 3584
    s_add_u32 m0, s57, 73728
    s_add_u32 s53, s53, s67
    buffer_load_dwordx4 v15, s[32:35], s53 offen lds
    buffer_load_dwordx4 v[40:43], v2, s[28:31], s79 offen
    s_waitcnt lgkmcnt(6)
    v_mfma_f32_32x32x16_bf16 v[56:71], v[36:39], v[164:167], v[56:71]
    ds_read_b64_tr_b16 v[36:37], v21 offset:63488
    ds_read_b64_tr_b16 v[38:39], v21 offset:64000
    s_waitcnt lgkmcnt(6)
    v_mfma_f32_32x32x16_bf16 v[72:87], v[24:27], v[152:155], v[72:87]
    ds_read_b64_tr_b16 v[24:25], v22 offset:0
    ds_read_b64_tr_b16 v[26:27], v22 offset:512
    s_mul_i32 s53, s12, 3584
    s_add_u32 m0, s57, 81920
    s_add_u32 s53, s53, s68
    buffer_load_dwordx4 v15, s[36:39], s53 offen lds
    s_waitcnt lgkmcnt(6)
    v_mfma_f32_32x32x16_bf16 v[72:87], v[28:31], v[156:159], v[72:87]
    ds_read_b64_tr_b16 v[28:29], v22 offset:2048
    ds_read_b64_tr_b16 v[30:31], v22 offset:2560
    s_waitcnt lgkmcnt(6)
    v_mfma_f32_32x32x16_bf16 v[72:87], v[32:35], v[160:163], v[72:87]
    ds_read_b64_tr_b16 v[32:33], v22 offset:4096
    ds_read_b64_tr_b16 v[34:35], v22 offset:4608
    s_lshl1_add_u32 s53, s13, s65
    s_add_u32 m0, s57, 16384
    s_add_u32 s53, s53, 0
    buffer_load_dwordx4 v13, s[28:31], s53 offen lds
    s_waitcnt lgkmcnt(6)
    v_mfma_f32_32x32x16_bf16 v[72:87], v[36:39], v[164:167], v[72:87]
    ds_read_b64_tr_b16 v[36:37], v22 offset:6144
    ds_read_b64_tr_b16 v[38:39], v22 offset:6656
    s_waitcnt lgkmcnt(6)
    v_mfma_f32_32x32x16_bf16 v[88:103], v[24:27], v[152:155], v[88:103]
    ds_read_b64_tr_b16 v[24:25], v22 offset:8192
    ds_read_b64_tr_b16 v[26:27], v22 offset:8704
    ds_read_b128 v[168:171], v16 offset:49152
    s_lshl1_add_u32 s53, s13, s65
    s_add_u32 m0, s57, 24576
    s_add_u32 s53, s53, 65536
    buffer_load_dwordx4 v13, s[28:31], s53 offen lds
    s_waitcnt lgkmcnt(7)
    v_mfma_f32_32x32x16_bf16 v[88:103], v[28:31], v[156:159], v[88:103]
    ds_read_b64_tr_b16 v[28:29], v22 offset:10240
    ds_read_b64_tr_b16 v[30:31], v22 offset:10752
    ds_read_b128 v[172:175], v17 offset:49152
    s_waitcnt lgkmcnt(8)
    v_mfma_f32_32x32x16_bf16 v[88:103], v[32:35], v[160:163], v[88:103]
    ds_read_b64_tr_b16 v[32:33], v22 offset:12288
    ds_read_b64_tr_b16 v[34:35], v22 offset:12800
    ds_read_b128 v[176:179], v18 offset:49152
    s_mul_i32 s53, s13, 3072
    s_add_u32 m0, s57, 90112
    s_add_u32 s53, s53, s66
    buffer_load_dwordx4 v14, s[40:43], s53 offen lds
    s_waitcnt lgkmcnt(9)
    s_waitcnt lgkmcnt(6)
    s_waitcnt vmcnt(6)
    v_mfma_f32_32x32x16_bf16 v[88:103], v[36:39], v[164:167], v[88:103]
    s_barrier
    v_mfma_f32_32x32x16_bf16 v[56:71], v[24:27], v[168:171], v[56:71]
    ds_read_b64_tr_b16 v[36:37], v22 offset:14336
    ds_read_b64_tr_b16 v[38:39], v22 offset:14848
    ds_read_b128 v[180:183], v19 offset:49152
    ds_read_b64_tr_b16 v[24:25], v22 offset:16384
    ds_read_b64_tr_b16 v[26:27], v22 offset:16896
    s_mul_i32 s53, s13, 3584
    s_add_u32 m0, s57, 98304
    s_add_u32 s53, s53, s67
    buffer_load_dwordx4 v15, s[32:35], s53 offen lds
    s_waitcnt lgkmcnt(8)
    v_mfma_f32_32x32x16_bf16 v[56:71], v[28:31], v[172:175], v[56:71]
    ds_read_b64_tr_b16 v[28:29], v22 offset:18432
    ds_read_b64_tr_b16 v[30:31], v22 offset:18944
    s_waitcnt lgkmcnt(7)
    v_mfma_f32_32x32x16_bf16 v[56:71], v[32:35], v[176:179], v[56:71]
    ds_read_b64_tr_b16 v[32:33], v22 offset:20480
    ds_read_b64_tr_b16 v[34:35], v22 offset:20992
    s_mul_i32 s53, s13, 3584
    s_add_u32 m0, s57, 106496
    s_add_u32 s53, s53, s68
    buffer_load_dwordx4 v15, s[36:39], s53 offen lds
    s_waitcnt lgkmcnt(6)
    v_mfma_f32_32x32x16_bf16 v[56:71], v[36:39], v[180:183], v[56:71]
    ds_read_b64_tr_b16 v[36:37], v22 offset:22528
    ds_read_b64_tr_b16 v[38:39], v22 offset:23040
    s_waitcnt lgkmcnt(6)
    v_mfma_f32_32x32x16_bf16 v[72:87], v[24:27], v[168:171], v[72:87]
    ds_read_b64_tr_b16 v[24:25], v22 offset:24576
    ds_read_b64_tr_b16 v[26:27], v22 offset:25088
    s_lshl1_add_u32 s53, s14, s65
    s_add_u32 m0, s57, 32768
    s_add_u32 s53, s53, 0
    buffer_load_dwordx4 v13, s[28:31], s53 offen lds
    s_waitcnt lgkmcnt(6)
    v_mfma_f32_32x32x16_bf16 v[72:87], v[28:31], v[172:175], v[72:87]
    ds_read_b64_tr_b16 v[28:29], v22 offset:26624
    ds_read_b64_tr_b16 v[30:31], v22 offset:27136
    s_waitcnt lgkmcnt(6)
    v_mfma_f32_32x32x16_bf16 v[72:87], v[32:35], v[176:179], v[72:87]
    ds_read_b64_tr_b16 v[32:33], v22 offset:28672
    ds_read_b64_tr_b16 v[34:35], v22 offset:29184
    s_lshl1_add_u32 s53, s14, s65
    s_add_u32 m0, s57, 40960
    s_add_u32 s53, s53, 65536
    buffer_load_dwordx4 v13, s[28:31], s53 offen lds
    s_waitcnt lgkmcnt(6)
    v_mfma_f32_32x32x16_bf16 v[72:87], v[36:39], v[180:183], v[72:87]
    ds_read_b64_tr_b16 v[36:37], v22 offset:30720
    ds_read_b64_tr_b16 v[38:39], v22 offset:31232
    s_waitcnt lgkmcnt(6)
    v_mfma_f32_32x32x16_bf16 v[88:103], v[24:27], v[168:171], v[88:103]
    ds_read_b64_tr_b16 v[24:25], v21 offset:0
    ds_read_b64_tr_b16 v[26:27], v21 offset:512
    ds_read_b128 v[184:187], v16 offset:0
    s_mul_i32 s53, s14, 3072
    s_add_u32 m0, s57, 114688
    s_add_u32 s53, s53, s66
    buffer_load_dwordx4 v14, s[40:43], s53 offen lds
    s_waitcnt lgkmcnt(7)
    v_mfma_f32_32x32x16_bf16 v[88:103], v[28:31], v[172:175], v[88:103]
    ds_read_b64_tr_b16 v[28:29], v21 offset:2048
    ds_read_b64_tr_b16 v[30:31], v21 offset:2560
    ds_read_b128 v[188:191], v17 offset:0
    s_waitcnt lgkmcnt(8)
    v_mfma_f32_32x32x16_bf16 v[88:103], v[32:35], v[176:179], v[88:103]
    ds_read_b64_tr_b16 v[32:33], v21 offset:4096
    ds_read_b64_tr_b16 v[34:35], v21 offset:4608
    ds_read_b128 v[192:195], v18 offset:0
    s_mul_i32 s53, s14, 3584
    s_add_u32 m0, s57, 122880
    s_add_u32 s53, s53, s67
    buffer_load_dwordx4 v15, s[32:35], s53 offen lds
    s_waitcnt lgkmcnt(9)
    s_waitcnt lgkmcnt(6)
    s_waitcnt vmcnt(6)
    v_mfma_f32_32x32x16_bf16 v[88:103], v[36:39], v[180:183], v[88:103]
    s_barrier
    v_mfma_f32_32x32x16_bf16 v[56:71], v[24:27], v[184:187], v[56:71]
    ds_read_b64_tr_b16 v[36:37], v21 offset:6144
    ds_read_b64_tr_b16 v[38:39], v21 offset:6656
    ds_read_b128 v[196:199], v19 offset:0
    ds_read_b64_tr_b16 v[24:25], v21 offset:8192
    ds_read_b64_tr_b16 v[26:27], v21 offset:8704
    s_mul_i32 s53, s14, 3584
    s_add_u32 m0, s57, 131072
    s_add_u32 s53, s53, s68
    buffer_load_dwordx4 v15, s[36:39], s53 offen lds
    s_waitcnt lgkmcnt(8)
    v_mfma_f32_32x32x16_bf16 v[56:71], v[28:31], v[188:191], v[56:71]
    ds_read_b64_tr_b16 v[28:29], v21 offset:10240
    ds_read_b64_tr_b16 v[30:31], v21 offset:10752
    s_waitcnt lgkmcnt(7)
    v_mfma_f32_32x32x16_bf16 v[56:71], v[32:35], v[192:195], v[56:71]
    ds_read_b64_tr_b16 v[32:33], v21 offset:12288
    ds_read_b64_tr_b16 v[34:35], v21 offset:12800
    s_lshl1_add_u32 s53, s15, s65
    s_add_u32 m0, s57, 49152
    s_add_u32 s53, s53, 0
    buffer_load_dwordx4 v13, s[28:31], s53 offen lds
    s_waitcnt lgkmcnt(6)
    v_mfma_f32_32x32x16_bf16 v[56:71], v[36:39], v[196:199], v[56:71]
    ds_read_b64_tr_b16 v[36:37], v21 offset:14336
    ds_read_b64_tr_b16 v[38:39], v21 offset:14848
    s_waitcnt lgkmcnt(6)
    v_mfma_f32_32x32x16_bf16 v[72:87], v[24:27], v[184:187], v[72:87]
    ds_read_b64_tr_b16 v[24:25], v21 offset:16384
    ds_read_b64_tr_b16 v[26:27], v21 offset:16896
    s_lshl1_add_u32 s53, s15, s65
    s_add_u32 m0, s57, 57344
    s_add_u32 s53, s53, 65536
    buffer_load_dwordx4 v13, s[28:31], s53 offen lds
    s_waitcnt lgkmcnt(6)
    v_mfma_f32_32x32x16_bf16 v[72:87], v[28:31], v[188:191], v[72:87]
    ds_read_b64_tr_b16 v[28:29], v21 offset:18432
    ds_read_b64_tr_b16 v[30:31], v21 offset:18944
    s_waitcnt lgkmcnt(6)
    v_mfma_f32_32x32x16_bf16 v[72:87], v[32:35], v[192:195], v[72:87]
    ds_read_b64_tr_b16 v[32:33], v21 offset:20480
    ds_read_b64_tr_b16 v[34:35], v21 offset:20992
    s_mul_i32 s53, s15, 3072
    s_add_u32 m0, s57, 139264
    s_add_u32 s53, s53, s66
    buffer_load_dwordx4 v14, s[40:43], s53 offen lds
    s_waitcnt lgkmcnt(6)
    v_mfma_f32_32x32x16_bf16 v[72:87], v[36:39], v[196:199], v[72:87]
    ds_read_b64_tr_b16 v[36:37], v21 offset:22528
    ds_read_b64_tr_b16 v[38:39], v21 offset:23040
    s_waitcnt lgkmcnt(6)
    v_mfma_f32_32x32x16_bf16 v[88:103], v[24:27], v[184:187], v[88:103]
    ds_read_b64_tr_b16 v[24:25], v21 offset:24576
    ds_read_b64_tr_b16 v[26:27], v21 offset:25088
    ds_read_b128 v[200:203], v16 offset:16384
    s_mul_i32 s53, s15, 3584
    s_add_u32 m0, s57, 147456
    s_add_u32 s53, s53, s67
    buffer_load_dwordx4 v15, s[32:35], s53 offen lds
    s_waitcnt lgkmcnt(7)
    v_mfma_f32_32x32x16_bf16 v[88:103], v[28:31], v[188:191], v[88:103]
    ds_read_b64_tr_b16 v[28:29], v21 offset:26624
    ds_read_b64_tr_b16 v[30:31], v21 offset:27136
    ds_read_b128 v[204:207], v17 offset:16384
    s_waitcnt lgkmcnt(8)
    v_mfma_f32_32x32x16_bf16 v[88:103], v[32:35], v[192:195], v[88:103]
    ds_read_b64_tr_b16 v[32:33], v21 offset:28672
    ds_read_b64_tr_b16 v[34:35], v21 offset:29184
    ds_read_b128 v[208:211], v18 offset:16384
    s_mul_i32 s53, s15, 3584
    s_add_u32 m0, s57, 155648
    s_add_u32 s53, s53, s68
    buffer_load_dwordx4 v15, s[36:39], s53 offen lds
    s_waitcnt lgkmcnt(9)
    s_waitcnt lgkmcnt(6)
    s_waitcnt vmcnt(7)
    v_mfma_f32_32x32x16_bf16 v[88:103], v[36:39], v[196:199], v[88:103]
    s_barrier
    v_mfma_f32_32x32x16_bf16 v[56:71], v[24:27], v[200:203], v[56:71]
    ds_read_b64_tr_b16 v[36:37], v21 offset:30720
    ds_read_b64_tr_b16 v[38:39], v21 offset:31232
    ds_read_b128 v[212:215], v19 offset:16384
    ds_read_b64_tr_b16 v[24:25], v21 offset:32768
    ds_read_b64_tr_b16 v[26:27], v21 offset:33280
    s_mul_i32 s53, s4, 3584
    s_add_u32 m0, s57, 65536
    s_add_u32 s53, s53, s69
    buffer_load_dwordx4 v15, s[32:35], s53 offen lds
    v_lshlrev_b32 v104, 16, v40
    v_and_b32 v105, 0xffff0000, v40
    s_waitcnt lgkmcnt(8)
    v_mfma_f32_32x32x16_bf16 v[56:71], v[28:31], v[204:207], v[56:71]
    ds_read_b64_tr_b16 v[28:29], v21 offset:34816
    ds_read_b64_tr_b16 v[30:31], v21 offset:35328
    v_lshlrev_b32 v112, 16, v44
    v_and_b32 v113, 0xffff0000, v44
    v_lshlrev_b32 v106, 16, v41
    s_waitcnt lgkmcnt(7)
    v_mfma_f32_32x32x16_bf16 v[56:71], v[32:35], v[208:211], v[56:71]
    ds_read_b64_tr_b16 v[32:33], v21 offset:36864
    ds_read_b64_tr_b16 v[34:35], v21 offset:37376
    s_mul_i32 s53, s5, 3584
    s_add_u32 m0, s57, 73728
    s_add_u32 s53, s53, s69
    buffer_load_dwordx4 v15, s[32:35], s53 offen lds
    v_and_b32 v107, 0xffff0000, v41
    v_lshlrev_b32 v114, 16, v45
    v_and_b32 v115, 0xffff0000, v45
    s_waitcnt lgkmcnt(6)
    v_mfma_f32_32x32x16_bf16 v[56:71], v[36:39], v[212:215], v[56:71]
    ds_read_b64_tr_b16 v[36:37], v21 offset:38912
    ds_read_b64_tr_b16 v[38:39], v21 offset:39424
    v_lshlrev_b32 v108, 16, v42
    v_and_b32 v109, 0xffff0000, v42
    v_lshlrev_b32 v116, 16, v46
    s_waitcnt lgkmcnt(6)
    v_mfma_f32_32x32x16_bf16 v[72:87], v[24:27], v[200:203], v[72:87]
    ds_read_b64_tr_b16 v[24:25], v21 offset:40960
    ds_read_b64_tr_b16 v[26:27], v21 offset:41472
    s_mul_i32 s53, s4, 3584
    s_add_u32 m0, s57, 81920
    s_add_u32 s53, s53, s70
    buffer_load_dwordx4 v15, s[36:39], s53 offen lds
    v_and_b32 v117, 0xffff0000, v46
    v_lshlrev_b32 v110, 16, v43
    v_and_b32 v111, 0xffff0000, v43
    s_waitcnt lgkmcnt(6)
    v_mfma_f32_32x32x16_bf16 v[72:87], v[28:31], v[204:207], v[72:87]
    ds_read_b64_tr_b16 v[28:29], v21 offset:43008
    ds_read_b64_tr_b16 v[30:31], v21 offset:43520
    v_lshlrev_b32 v118, 16, v47
    v_and_b32 v119, 0xffff0000, v47
    s_waitcnt lgkmcnt(6)
    v_mfma_f32_32x32x16_bf16 v[72:87], v[32:35], v[208:211], v[72:87]
    ds_read_b64_tr_b16 v[32:33], v21 offset:45056
    ds_read_b64_tr_b16 v[34:35], v21 offset:45568
    s_mul_i32 s53, s5, 3584
    s_add_u32 m0, s57, 0
    s_add_u32 s53, s53, s70
    buffer_load_dwordx4 v15, s[36:39], s53 offen lds
    v_mul_f32 v104, v104, v112
    v_mul_f32 v105, v105, v113
    v_mul_f32 v106, v106, v114
    s_waitcnt lgkmcnt(6)
    v_mfma_f32_32x32x16_bf16 v[72:87], v[36:39], v[212:215], v[72:87]
    ds_read_b64_tr_b16 v[36:37], v21 offset:47104
    ds_read_b64_tr_b16 v[38:39], v21 offset:47616
    v_mul_f32 v107, v107, v115
    v_mul_f32 v108, v108, v116
    v_mul_f32 v109, v109, v117
    s_waitcnt lgkmcnt(6)
    v_mfma_f32_32x32x16_bf16 v[88:103], v[24:27], v[200:203], v[88:103]
    ds_read_b64_tr_b16 v[24:25], v21 offset:49152
    ds_read_b64_tr_b16 v[26:27], v21 offset:49664
    ds_read_b128 v[216:219], v16 offset:32768
    s_mul_i32 s53, s6, 3584
    s_add_u32 m0, s57, 8192
    s_add_u32 s53, s53, s69
    buffer_load_dwordx4 v15, s[32:35], s53 offen lds
    v_mul_f32 v110, v110, v118
    v_mul_f32 v111, v111, v119
    v_cvt_pk_bf16_f32 v112, v104, v105
    s_waitcnt lgkmcnt(7)
    v_mfma_f32_32x32x16_bf16 v[88:103], v[28:31], v[204:207], v[88:103]
    ds_read_b64_tr_b16 v[28:29], v21 offset:51200
    ds_read_b64_tr_b16 v[30:31], v21 offset:51712
    ds_read_b128 v[220:223], v17 offset:32768
    v_cvt_pk_bf16_f32 v113, v106, v107
    v_cvt_pk_bf16_f32 v114, v108, v109
    v_cvt_pk_bf16_f32 v115, v110, v111
    s_waitcnt lgkmcnt(8)
    v_mfma_f32_32x32x16_bf16 v[88:103], v[32:35], v[208:211], v[88:103]
    ds_read_b64_tr_b16 v[32:33], v21 offset:53248
    ds_read_b64_tr_b16 v[34:35], v21 offset:53760
    ds_read_b128 v[224:227], v18 offset:32768
    v_lshlrev_b32 v104, 16, v112
    v_and_b32 v105, 0xffff0000, v112
    s_waitcnt lgkmcnt(9)
    s_waitcnt lgkmcnt(6)
    s_waitcnt vmcnt(7)
    v_mfma_f32_32x32x16_bf16 v[88:103], v[36:39], v[212:215], v[88:103]
    s_barrier
    v_mfma_f32_32x32x16_bf16 v[56:71], v[24:27], v[216:219], v[56:71]
    ds_read_b64_tr_b16 v[36:37], v21 offset:55296
    ds_read_b64_tr_b16 v[38:39], v21 offset:55808
    ds_read_b128 v[228:231], v19 offset:32768
    ds_read_b64_tr_b16 v[24:25], v21 offset:57344
    ds_read_b64_tr_b16 v[26:27], v21 offset:57856
    s_mul_i32 s53, s7, 3584
    s_add_u32 m0, s57, 90112
    s_add_u32 s53, s53, s69
    buffer_load_dwordx4 v15, s[32:35], s53 offen lds
    v_lshlrev_b32 v106, 16, v113
    v_and_b32 v107, 0xffff0000, v113
    v_lshlrev_b32 v108, 16, v114
    s_waitcnt lgkmcnt(8)
    v_mfma_f32_32x32x16_bf16 v[56:71], v[28:31], v[220:223], v[56:71]
    ds_read_b64_tr_b16 v[28:29], v21 offset:59392
    ds_read_b64_tr_b16 v[30:31], v21 offset:59904
    v_and_b32 v109, 0xffff0000, v114
    v_lshlrev_b32 v110, 16, v115
    v_and_b32 v111, 0xffff0000, v115
    s_waitcnt lgkmcnt(7)
    v_mfma_f32_32x32x16_bf16 v[56:71], v[32:35], v[224:227], v[56:71]
    ds_read_b64_tr_b16 v[32:33], v21 offset:61440
    ds_read_b64_tr_b16 v[34:35], v21 offset:61952
    s_mul_i32 s53, s12, 3584
    s_add_u32 m0, s57, 98304
    s_add_u32 s53, s53, s69
    buffer_load_dwordx4 v15, s[32:35], s53 offen lds
    v_add_f32 v104, v104, v108
    v_add_f32 v105, v105, v109
    v_add_f32 v106, v106, v110
    s_waitcnt lgkmcnt(6)
    v_mfma_f32_32x32x16_bf16 v[56:71], v[36:39], v[228:231], v[56:71]
    ds_read_b64_tr_b16 v[36:37], v21 offset:63488
    ds_read_b64_tr_b16 v[38:39], v21 offset:64000
    v_add_f32 v107, v107, v111
    v_add_f32 v104, v104, v106
    v_add_f32 v105, v105, v107
    s_waitcnt lgkmcnt(6)
    v_mfma_f32_32x32x16_bf16 v[72:87], v[24:27], v[216:219], v[72:87]
    ds_read_b64_tr_b16 v[24:25], v22 offset:0
    ds_read_b64_tr_b16 v[26:27], v22 offset:512
    s_mul_i32 s53, s13, 3584
    s_add_u32 m0, s57, 106496
    s_add_u32 s53, s53, s69
    buffer_load_dwordx4 v15, s[32:35], s53 offen lds
    v_add_f32 v104, v104, v105
    s_nop 1
    v_add_f32_dpp v104, v104, v104 row_ror:8 row_mask:0xf bank_mask:0xf
    s_nop 1
    v_add_f32_dpp v104, v104, v104 row_ror:4 row_mask:0xf bank_mask:0xf
    s_waitcnt lgkmcnt(6)
    v_mfma_f32_32x32x16_bf16 v[72:87], v[28:31], v[220:223], v[72:87]
    ds_read_b64_tr_b16 v[28:29], v22 offset:2048
    ds_read_b64_tr_b16 v[30:31], v22 offset:2560
    v_add_f32_dpp v104, v104, v104 row_ror:2 row_mask:0xf bank_mask:0xf
    s_nop 1
    v_add_f32_dpp v104, v104, v104 row_ror:1 row_mask:0xf bank_mask:0xf
    s_waitcnt lgkmcnt(6)
    v_mfma_f32_32x32x16_bf16 v[72:87], v[32:35], v[224:227], v[72:87]
    ds_read_b64_tr_b16 v[32:33], v22 offset:4096
    ds_read_b64_tr_b16 v[34:35], v22 offset:4608
    s_mul_i32 s53, s14, 3584
    s_add_u32 m0, s57, 16384
    s_add_u32 s53, s53, s69
    buffer_load_dwordx4 v15, s[32:35], s53 offen lds
    v_mov_b32 v105, v104
    s_nop 1
    v_permlane16_swap_b32 v104, v105
    v_add_f32 v104, v104, v105
    s_waitcnt lgkmcnt(6)
    v_mfma_f32_32x32x16_bf16 v[72:87], v[36:39], v[228:231], v[72:87]
    ds_read_b64_tr_b16 v[36:37], v22 offset:6144
    ds_read_b64_tr_b16 v[38:39], v22 offset:6656
    v_mov_b32 v105, v104
    s_nop 1
    v_permlane32_swap_b32 v104, v105
    v_add_f32 v104, v104, v105
    s_waitcnt lgkmcnt(6)
    v_mfma_f32_32x32x16_bf16 v[88:103], v[24:27], v[216:219], v[88:103]
    ds_read_b64_tr_b16 v[24:25], v22 offset:8192
    ds_read_b64_tr_b16 v[26:27], v22 offset:8704
    ds_read_b128 v[232:235], v16 offset:49152
    s_mul_i32 s53, s15, 3584
    s_add_u32 m0, s57, 24576
    s_add_u32 s53, s53, s69
    buffer_load_dwordx4 v15, s[32:35], s53 offen lds
    v_cvt_pk_bf16_f32 v104, v104, v104
    v_lshlrev_b32 v104, 16, v104
    v_mul_f32 v104, 0xbfb8aa3b, v104
    s_waitcnt lgkmcnt(7)
    v_mfma_f32_32x32x16_bf16 v[88:103], v[28:31], v[220:223], v[88:103]
    ds_read_b64_tr_b16 v[28:29], v22 offset:10240
    ds_read_b64_tr_b16 v[30:31], v22 offset:10752
    ds_read_b128 v[236:239], v17 offset:49152
    v_exp_f32 v104, v104
    s_nop 0
    v_add_f32 v104, 1.0, v104
    v_rcp_f32 v104, v104
    s_waitcnt lgkmcnt(8)
    v_mfma_f32_32x32x16_bf16 v[88:103], v[32:35], v[224:227], v[88:103]
    ds_read_b64_tr_b16 v[32:33], v22 offset:12288
    ds_read_b64_tr_b16 v[34:35], v22 offset:12800
    ds_read_b128 v[240:243], v18 offset:49152
    v_cvt_pk_bf16_f32 v104, v104, v104
    v_lshlrev_b32 v10, 16, v104
    s_waitcnt lgkmcnt(9)
    s_waitcnt lgkmcnt(6)
    s_waitcnt vmcnt(9)
    v_mfma_f32_32x32x16_bf16 v[88:103], v[36:39], v[228:231], v[88:103]
    s_barrier
    v_mfma_f32_32x32x16_bf16 v[56:71], v[24:27], v[232:235], v[56:71]
    ds_read_b64_tr_b16 v[36:37], v22 offset:14336
    ds_read_b64_tr_b16 v[38:39], v22 offset:14848
    ds_read_b128 v[244:247], v19 offset:49152
    ds_read_b64_tr_b16 v[24:25], v22 offset:16384
    ds_read_b64_tr_b16 v[26:27], v22 offset:16896
    s_mul_i32 s53, s6, 3584
    s_add_u32 m0, s57, 114688
    s_add_u32 s53, s53, s70
    buffer_load_dwordx4 v15, s[36:39], s53 offen lds
    s_waitcnt lgkmcnt(8)
    v_mfma_f32_32x32x16_bf16 v[56:71], v[28:31], v[236:239], v[56:71]
    ds_read_b64_tr_b16 v[28:29], v22 offset:18432
    ds_read_b64_tr_b16 v[30:31], v22 offset:18944
    s_waitcnt lgkmcnt(7)
    v_mfma_f32_32x32x16_bf16 v[56:71], v[32:35], v[240:243], v[56:71]
    ds_read_b64_tr_b16 v[32:33], v22 offset:20480
    ds_read_b64_tr_b16 v[34:35], v22 offset:20992
    s_mul_i32 s53, s7, 3584
    s_add_u32 m0, s57, 122880
    s_add_u32 s53, s53, s70
    buffer_load_dwordx4 v15, s[36:39], s53 offen lds
    s_waitcnt lgkmcnt(6)
    v_mfma_f32_32x32x16_bf16 v[56:71], v[36:39], v[244:247], v[56:71]
    ds_read_b64_tr_b16 v[36:37], v22 offset:22528
    ds_read_b64_tr_b16 v[38:39], v22 offset:23040
    s_waitcnt lgkmcnt(6)
    v_mfma_f32_32x32x16_bf16 v[72:87], v[24:27], v[232:235], v[72:87]
    ds_read_b64_tr_b16 v[24:25], v22 offset:24576
    ds_read_b64_tr_b16 v[26:27], v22 offset:25088
    s_mul_i32 s53, s12, 3584
    s_add_u32 m0, s57, 131072
    s_add_u32 s53, s53, s70
    buffer_load_dwordx4 v15, s[36:39], s53 offen lds
    v_mov_b32 v6, 0
    buffer_load_dwordx2 v[250:251], v6, s[48:51], 0 offen sc1
    s_waitcnt lgkmcnt(6)
    v_mfma_f32_32x32x16_bf16 v[72:87], v[28:31], v[236:239], v[72:87]
    ds_read_b64_tr_b16 v[28:29], v22 offset:26624
    ds_read_b64_tr_b16 v[30:31], v22 offset:27136
    s_waitcnt lgkmcnt(6)
    v_mfma_f32_32x32x16_bf16 v[72:87], v[32:35], v[240:243], v[72:87]
    ds_read_b64_tr_b16 v[32:33], v22 offset:28672
    ds_read_b64_tr_b16 v[34:35], v22 offset:29184
    s_mul_i32 s53, s13, 3584
    s_add_u32 m0, s57, 32768
    s_add_u32 s53, s53, s70
    buffer_load_dwordx4 v15, s[36:39], s53 offen lds
    s_waitcnt lgkmcnt(6)
    v_mfma_f32_32x32x16_bf16 v[72:87], v[36:39], v[244:247], v[72:87]
    ds_read_b64_tr_b16 v[36:37], v22 offset:30720
    ds_read_b64_tr_b16 v[38:39], v22 offset:31232
    s_waitcnt lgkmcnt(6)
    v_mfma_f32_32x32x16_bf16 v[88:103], v[24:27], v[232:235], v[88:103]
    ds_read_b64_tr_b16 v[24:25], v21 offset:0
    ds_read_b64_tr_b16 v[26:27], v21 offset:512
    s_mul_i32 s53, s14, 3584
    s_add_u32 m0, s57, 40960
    s_add_u32 s53, s53, s70
    buffer_load_dwordx4 v15, s[36:39], s53 offen lds
    s_waitcnt lgkmcnt(6)
    v_mfma_f32_32x32x16_bf16 v[88:103], v[28:31], v[236:239], v[88:103]
    ds_read_b64_tr_b16 v[28:29], v21 offset:2048
    ds_read_b64_tr_b16 v[30:31], v21 offset:2560
    s_waitcnt lgkmcnt(6)
    v_mfma_f32_32x32x16_bf16 v[88:103], v[32:35], v[240:243], v[88:103]
    ds_read_b64_tr_b16 v[32:33], v21 offset:4096
    ds_read_b64_tr_b16 v[34:35], v21 offset:4608
    s_waitcnt lgkmcnt(6)
    s_waitcnt lgkmcnt(4)
    s_waitcnt vmcnt(9)
    v_mfma_f32_32x32x16_bf16 v[88:103], v[36:39], v[244:247], v[88:103]
    s_barrier
    v_mfma_f32_32x32x16_bf16 v[104:119], v[24:27], v[120:123], 0
    ds_read_b64_tr_b16 v[36:37], v21 offset:6144
    ds_read_b64_tr_b16 v[38:39], v21 offset:6656
    ds_read_b64_tr_b16 v[24:25], v21 offset:8192
    ds_read_b64_tr_b16 v[26:27], v21 offset:8704
    s_mul_i32 s53, s15, 3584
    s_add_u32 m0, s57, 139264
    s_add_u32 s53, s53, s70
    buffer_load_dwordx4 v15, s[36:39], s53 offen lds
    s_waitcnt lgkmcnt(6)
    v_mfma_f32_32x32x16_bf16 v[104:119], v[28:31], v[124:127], v[104:119]
    ds_read_b64_tr_b16 v[28:29], v21 offset:10240
    ds_read_b64_tr_b16 v[30:31], v21 offset:10752
    s_waitcnt lgkmcnt(6)
    v_mfma_f32_32x32x16_bf16 v[104:119], v[32:35], v[128:131], v[104:119]
    ds_read_b64_tr_b16 v[32:33], v21 offset:12288
    ds_read_b64_tr_b16 v[34:35], v21 offset:12800
    v_mul_f32 v56, s72, v56
    v_mul_f32 v57, s72, v57
    v_mul_f32 v58, s72, v58
    v_mul_f32 v59, s72, v59
    v_mul_f32 v60, s72, v60
    s_waitcnt lgkmcnt(6)
    v_mfma_f32_32x32x16_bf16 v[104:119], v[36:39], v[132:135], v[104:119]
    ds_read_b64_tr_b16 v[36:37], v21 offset:14336
    ds_read_b64_tr_b16 v[38:39], v21 offset:14848
    v_mul_f32 v61, s72, v61
    v_mul_f32 v62, s72, v62
    v_mul_f32 v63, s72, v63
    v_mul_f32 v64, s72, v64
    s_waitcnt lgkmcnt(6)
    v_mfma_f32_32x32x16_bf16 v[104:119], v[24:27], v[136:139], v[104:119]
    ds_read_b64_tr_b16 v[24:25], v20 offset:8192
    ds_read_b64_tr_b16 v[26:27], v20 offset:8704
    v_mul_f32 v65, s72, v65
    v_mul_f32 v66, s72, v66
    v_mul_f32 v67, s72, v67
    v_mul_f32 v68, s72, v68
    s_waitcnt lgkmcnt(6)
    v_mfma_f32_32x32x16_bf16 v[104:119], v[28:31], v[140:143], v[104:119]
    ds_read_b64_tr_b16 v[28:29], v20 offset:10240
    ds_read_b64_tr_b16 v[30:31], v20 offset:10752
    v_mul_f32 v69, s72, v69
    v_mul_f32 v70, s72, v70
    v_mul_f32 v71, s72, v71
    v_cvt_pk_bf16_f32 v48, v56, v57
    v_cvt_pk_bf16_f32 v49, v58, v59
    s_waitcnt lgkmcnt(6)
    v_mfma_f32_32x32x16_bf16 v[104:119], v[32:35], v[144:147], v[104:119]
    ds_read_b64_tr_b16 v[32:33], v20 offset:12288
    ds_read_b64_tr_b16 v[34:35], v20 offset:12800
    v_cvt_pk_bf16_f32 v50, v60, v61
    v_cvt_pk_bf16_f32 v51, v62, v63
    v_cvt_pk_bf16_f32 v52, v64, v65
    v_cvt_pk_bf16_f32 v53, v66, v67
    s_waitcnt lgkmcnt(6)
    v_mfma_f32_32x32x16_bf16 v[104:119], v[36:39], v[148:151], v[104:119]
    ds_read_b64_tr_b16 v[36:37], v20 offset:14336
    ds_read_b64_tr_b16 v[38:39], v20 offset:14848
    v_cvt_pk_bf16_f32 v54, v68, v69
    v_cvt_pk_bf16_f32 v55, v70, v71
    s_add_u32 s54, s71, 65536
    buffer_store_dwordx4 v[48:51], v2, s[44:47], s71 offen sc1
    buffer_store_dwordx4 v[52:55], v2, s[44:47], s54 offen sc1
    v_mov_b32 v3, 0
    s_mov_b64 exec, 1
    buffer_store_dword v10, v3, s[44:47], s78 offen sc1
    s_mov_b64 exec, -1
    s_waitcnt lgkmcnt(6)
    v_mfma_f32_32x32x16_bf16 v[104:119], v[24:27], v[152:155], v[104:119]
    ds_read_b64_tr_b16 v[24:25], v21 offset:24576
    ds_read_b64_tr_b16 v[26:27], v21 offset:25088
    v_mul_f32 v40, v72, v72
    v_mul_f32 v41, v73, v73
    v_mul_f32 v42, v74, v74
    v_mul_f32 v43, v75, v75
    v_mul_f32 v44, v76, v76
    s_waitcnt lgkmcnt(6)
    v_mfma_f32_32x32x16_bf16 v[104:119], v[28:31], v[156:159], v[104:119]
    ds_read_b64_tr_b16 v[28:29], v21 offset:26624
    ds_read_b64_tr_b16 v[30:31], v21 offset:27136
    v_mul_f32 v45, v77, v77
    v_mul_f32 v46, v78, v78
    v_mul_f32 v47, v79, v79
    v_fma_f32 v40, v40, s74, v248
    v_fma_f32 v41, v41, s74, v248
    s_waitcnt lgkmcnt(6)
    v_mfma_f32_32x32x16_bf16 v[104:119], v[32:35], v[160:163], v[104:119]
    ds_read_b64_tr_b16 v[32:33], v21 offset:28672
    ds_read_b64_tr_b16 v[34:35], v21 offset:29184
    v_fma_f32 v42, v42, s74, v248
    v_fma_f32 v43, v43, s74, v248
    v_fma_f32 v44, v44, s74, v248
    v_fma_f32 v45, v45, s74, v248
    v_add_u32 v13, s89, v2
    s_waitcnt lgkmcnt(6)
    v_mfma_f32_32x32x16_bf16 v[104:119], v[36:39], v[164:167], v[104:119]
    ds_read_b64_tr_b16 v[36:37], v21 offset:30720
    ds_read_b64_tr_b16 v[38:39], v21 offset:31232
    v_fma_f32 v46, v46, s74, v248
    v_fma_f32 v47, v47, s74, v248
    v_mul_f32 v40, v40, v72
    v_mul_f32 v41, v41, v73
    v_mul_f32 v42, v42, v74
    v_lshrrev_b32 v7, 5, v1
    s_waitcnt lgkmcnt(6)
    v_mfma_f32_32x32x16_bf16 v[104:119], v[24:27], v[168:171], v[104:119]
    ds_read_b64_tr_b16 v[24:25], v21 offset:32768
    ds_read_b64_tr_b16 v[26:27], v21 offset:33280
    v_mul_f32 v43, v43, v75
    v_mul_f32 v44, v44, v76
    v_mul_f32 v45, v45, v77
    v_mul_f32 v46, v46, v78
    v_lshlrev_b32 v14, 8, v7
    s_waitcnt lgkmcnt(6)
    v_mfma_f32_32x32x16_bf16 v[104:119], v[28:31], v[172:175], v[104:119]
    ds_read_b64_tr_b16 v[28:29], v21 offset:34816
    ds_read_b64_tr_b16 v[30:31], v21 offset:35328
    v_mul_f32 v47, v47, v79
    v_exp_f32 v40, v40
    v_mul_f32 v88, v88, v72
    v_exp_f32 v41, v41
    v_mul_f32 v89, v89, v73
    v_and_b32 v8, 15, v1
    s_waitcnt lgkmcnt(6)
    v_mfma_f32_32x32x16_bf16 v[104:119], v[32:35], v[176:179], v[104:119]
    ds_read_b64_tr_b16 v[32:33], v21 offset:36864
    ds_read_b64_tr_b16 v[34:35], v21 offset:37376
    v_exp_f32 v42, v42
    v_mul_f32 v90, v90, v74
    v_exp_f32 v43, v43
    v_mul_f32 v91, v91, v75
    v_lshl_add_u32 v14, v8, 4, v14
    s_waitcnt lgkmcnt(6)
    s_waitcnt lgkmcnt(4)
    s_waitcnt vmcnt(10)
    v_mfma_f32_32x32x16_bf16 v[104:119], v[36:39], v[180:183], v[104:119]
    s_barrier
    v_mfma_f32_32x32x16_bf16 v[104:119], v[24:27], v[184:187], v[104:119]
    ds_read_b64_tr_b16 v[36:37], v21 offset:38912
    ds_read_b64_tr_b16 v[38:39], v21 offset:39424
    ds_read_b64_tr_b16 v[24:25], v21 offset:40960
    ds_read_b64_tr_b16 v[26:27], v21 offset:41472
    v_exp_f32 v44, v44
    v_mul_f32 v92, v92, v76
    v_exp_f32 v45, v45
    v_mul_f32 v93, v93, v77
    v_exp_f32 v46, v46
    v_add_u32 v14, 65536, v14
    s_waitcnt lgkmcnt(6)
    v_mfma_f32_32x32x16_bf16 v[104:119], v[28:31], v[188:191], v[104:119]
    ds_read_b64_tr_b16 v[28:29], v21 offset:43008
    ds_read_b64_tr_b16 v[30:31], v21 offset:43520
    v_mul_f32 v94, v94, v78
    v_exp_f32 v47, v47
    v_mul_f32 v95, v95, v79
    v_add_f32 v40, 1.0, v40
    v_add_f32 v41, 1.0, v41
    v_add_u32 v14, s89, v14
    s_waitcnt lgkmcnt(6)
    v_mfma_f32_32x32x16_bf16 v[104:119], v[32:35], v[192:195], v[104:119]
    ds_read_b64_tr_b16 v[32:33], v21 offset:45056
    ds_read_b64_tr_b16 v[34:35], v21 offset:45568
    v_add_f32 v42, 1.0, v42
    v_add_f32 v43, 1.0, v43
    v_add_f32 v44, 1.0, v44
    v_add_f32 v45, 1.0, v45
    v_lshlrev_b32 v7, 9, v7
    s_waitcnt lgkmcnt(6)
    v_mfma_f32_32x32x16_bf16 v[104:119], v[36:39], v[196:199], v[104:119]
    ds_read_b64_tr_b16 v[36:37], v21 offset:47104
    ds_read_b64_tr_b16 v[38:39], v21 offset:47616
    v_add_f32 v46, 1.0, v46
    v_add_f32 v47, 1.0, v47
    v_rcp_f32 v40, v40
    v_rcp_f32 v41, v41
    v_rcp_f32 v42, v42
    s_waitcnt lgkmcnt(6)
    v_mfma_f32_32x32x16_bf16 v[104:119], v[24:27], v[200:203], v[104:119]
    ds_read_b64_tr_b16 v[24:25], v20 offset:16384
    ds_read_b64_tr_b16 v[26:27], v20 offset:16896
    v_rcp_f32 v43, v43
    v_rcp_f32 v44, v44
    v_rcp_f32 v45, v45
    v_rcp_f32 v46, v46
    v_bfe_u32 v8, v1, 2, 2
    s_waitcnt lgkmcnt(6)
    v_mfma_f32_32x32x16_bf16 v[104:119], v[28:31], v[204:207], v[104:119]
    ds_read_b64_tr_b16 v[28:29], v20 offset:18432
    ds_read_b64_tr_b16 v[30:31], v20 offset:18944
    v_rcp_f32 v47, v47
    v_mul_f32 v88, v88, v40
    v_mul_f32 v89, v89, v41
    v_mul_f32 v90, v90, v42
    v_mul_f32 v91, v91, v43
    v_lshl_add_u32 v7, v8, 7, v7
    s_waitcnt lgkmcnt(6)
    v_mfma_f32_32x32x16_bf16 v[104:119], v[32:35], v[208:211], v[104:119]
    ds_read_b64_tr_b16 v[32:33], v20 offset:20480
    ds_read_b64_tr_b16 v[34:35], v20 offset:20992
    v_mul_f32 v92, v92, v44
    v_mul_f32 v93, v93, v45
    v_mul_f32 v94, v94, v46
    v_mul_f32 v95, v95, v47
    v_bfe_u32 v8, v1, 3, 1
    s_waitcnt lgkmcnt(6)
    v_mfma_f32_32x32x16_bf16 v[104:119], v[36:39], v[212:215], v[104:119]
    ds_read_b64_tr_b16 v[36:37], v20 offset:22528
    ds_read_b64_tr_b16 v[38:39], v20 offset:23040
    v_mul_f32 v40, v80, v80
    v_mul_f32 v41, v81, v81
    v_mul_f32 v42, v82, v82
    v_mul_f32 v43, v83, v83
    v_mul_f32 v44, v84, v84
    v_lshl_add_u32 v7, v8, 6, v7
    s_waitcnt lgkmcnt(6)
    v_mfma_f32_32x32x16_bf16 v[104:119], v[24:27], v[216:219], v[104:119]
    ds_read_b64_tr_b16 v[24:25], v20 offset:24576
    ds_read_b64_tr_b16 v[26:27], v20 offset:25088
    v_mul_f32 v45, v85, v85
    v_mul_f32 v46, v86, v86
    v_mul_f32 v47, v87, v87
    v_fma_f32 v40, v40, s74, v248
    v_fma_f32 v41, v41, s74, v248
    v_bfe_u32 v8, v1, 4, 1
    s_waitcnt lgkmcnt(6)
    v_mfma_f32_32x32x16_bf16 v[104:119], v[28:31], v[220:223], v[104:119]
    ds_read_b64_tr_b16 v[28:29], v20 offset:26624
    ds_read_b64_tr_b16 v[30:31], v20 offset:27136
    v_fma_f32 v42, v42, s74, v248
    v_fma_f32 v43, v43, s74, v248
    v_fma_f32 v44, v44, s74, v248
    v_fma_f32 v45, v45, s74, v248
    v_lshl_add_u32 v7, v8, 5, v7
    s_waitcnt lgkmcnt(6)
    v_mfma_f32_32x32x16_bf16 v[104:119], v[32:35], v[224:227], v[104:119]
    ds_read_b64_tr_b16 v[32:33], v20 offset:28672
    ds_read_b64_tr_b16 v[34:35], v20 offset:29184
    v_fma_f32 v46, v46, s74, v248
    v_fma_f32 v47, v47, s74, v248
    v_mul_f32 v40, v40, v80
    v_mul_f32 v41, v41, v81
    v_mul_f32 v42, v42, v82
    v_and_b32 v8, 3, v1
    s_waitcnt lgkmcnt(6)
    v_mfma_f32_32x32x16_bf16 v[104:119], v[36:39], v[228:231], v[104:119]
    ds_read_b64_tr_b16 v[36:37], v20 offset:30720
    ds_read_b64_tr_b16 v[38:39], v20 offset:31232
    v_mul_f32 v43, v43, v83
    v_mul_f32 v44, v44, v84
    v_mul_f32 v45, v45, v85
    v_mul_f32 v46, v46, v86
    v_lshl_add_u32 v7, v8, 3, v7
    s_waitcnt lgkmcnt(6)
    v_mfma_f32_32x32x16_bf16 v[104:119], v[24:27], v[232:235], v[104:119]
    ds_read_b64_tr_b16 v[24:25], v21 offset:16384
    ds_read_b64_tr_b16 v[26:27], v21 offset:16896
    v_mul_f32 v47, v47, v87
    v_exp_f32 v40, v40
    v_mul_f32 v96, v96, v80
    v_exp_f32 v41, v41
    v_mul_f32 v97, v97, v81
    s_waitcnt lgkmcnt(6)
    v_mfma_f32_32x32x16_bf16 v[104:119], v[28:31], v[236:239], v[104:119]
    ds_read_b64_tr_b16 v[28:29], v21 offset:18432
    ds_read_b64_tr_b16 v[30:31], v21 offset:18944
    v_exp_f32 v42, v42
    v_mul_f32 v98, v98, v82
    v_exp_f32 v43, v43
    v_mul_f32 v99, v99, v83
    s_lshl_b32 s55, s3, 5
    s_waitcnt lgkmcnt(6)
    v_mfma_f32_32x32x16_bf16 v[104:119], v[32:35], v[240:243], v[104:119]
    ds_read_b64_tr_b16 v[32:33], v21 offset:20480
    ds_read_b64_tr_b16 v[34:35], v21 offset:20992
    v_exp_f32 v44, v44
    v_mul_f32 v100, v100, v84
    v_exp_f32 v45, v45
    v_mul_f32 v101, v101, v85
    v_exp_f32 v46, v46
    v_xor_b32 v7, s55, v7
    s_waitcnt lgkmcnt(6)
    s_waitcnt lgkmcnt(4)
    s_waitcnt vmcnt(0)
    s_mov_b32 s56, 0
L_non1:
    v_readfirstlane_b32 s58, v250
    v_readfirstlane_b32 s59, v251
    s_cmp_lg_u32 s58, 0
    s_cbranch_scc1 L_nond2
    s_sleep 8
    buffer_load_dwordx2 v[250:251], v6, s[48:51], 0 offen sc1
    s_waitcnt vmcnt(0)
    s_add_u32 s56, s56, 1
    s_cmp_lt_u32 s56, 40000
    s_cbranch_scc1 L_non1
L_nond2:
    v_mfma_f32_32x32x16_bf16 v[104:119], v[36:39], v[244:247], v[104:119]
    s_barrier
    v_mfma_f32_32x32x16_bf16 v[56:71], v[24:27], v[120:123], 0
    ds_read_b64_tr_b16 v[36:37], v21 offset:22528
    ds_read_b64_tr_b16 v[38:39], v21 offset:23040
    ds_read_b64_tr_b16 v[24:25], v20 offset:0
    ds_read_b64_tr_b16 v[26:27], v20 offset:512
    v_mul_f32 v102, v102, v86
    v_exp_f32 v47, v47
    v_mul_f32 v103, v103, v87
    v_add_f32 v40, 1.0, v40
    v_add_f32 v41, 1.0, v41
    v_mov_b32 v4, s58
    v_mov_b32 v5, s59
    v_mov_b32 v3, 0
    s_mov_b64 exec, 1
    buffer_store_dwordx2 v[4:5], v3, s[44:47], s94 offen sc1
    s_mov_b64 exec, -1
    v_add_u32 v18, s84, v7
    s_waitcnt lgkmcnt(6)
    v_mfma_f32_32x32x16_bf16 v[56:71], v[28:31], v[124:127], v[56:71]
    ds_read_b64_tr_b16 v[28:29], v20 offset:2048
    ds_read_b64_tr_b16 v[30:31], v20 offset:2560
    v_add_f32 v42, 1.0, v42
    v_add_f32 v43, 1.0, v43
    v_add_f32 v44, 1.0, v44
    v_add_f32 v45, 1.0, v45
    v_xor_b32 v19, 64, v18
    s_waitcnt lgkmcnt(6)
    v_mfma_f32_32x32x16_bf16 v[56:71], v[32:35], v[128:131], v[56:71]
    ds_read_b64_tr_b16 v[32:33], v20 offset:4096
    ds_read_b64_tr_b16 v[34:35], v20 offset:4608
    v_add_f32 v46, 1.0, v46
    v_add_f32 v47, 1.0, v47
    v_rcp_f32 v40, v40
    v_rcp_f32 v41, v41
    v_rcp_f32 v42, v42
    v_and_b32 v7, 7, v1
    s_waitcnt lgkmcnt(6)
    v_mfma_f32_32x32x16_bf16 v[56:71], v[36:39], v[132:135], v[56:71]
    ds_read_b64_tr_b16 v[36:37], v20 offset:6144
    ds_read_b64_tr_b16 v[38:39], v20 offset:6656
    v_rcp_f32 v43, v43
    v_rcp_f32 v44, v44
    v_rcp_f32 v45, v45
    v_rcp_f32 v46, v46
    v_lshrrev_b32 v8, 2, v1
    s_waitcnt lgkmcnt(6)
    v_mfma_f32_32x32x16_bf16 v[56:71], v[24:27], v[136:139], v[56:71]
    ds_read_b64_tr_b16 v[24:25], v21 offset:49152
    ds_read_b64_tr_b16 v[26:27], v21 offset:49664
    v_rcp_f32 v47, v47
    v_mul_f32 v96, v96, v40
    v_mul_f32 v97, v97, v41
    v_mul_f32 v98, v98, v42
    v_mul_f32 v99, v99, v43
    v_and_b32 v8, 4, v8
    s_waitcnt lgkmcnt(6)
    v_mfma_f32_32x32x16_bf16 v[56:71], v[28:31], v[140:143], v[56:71]
    ds_read_b64_tr_b16 v[28:29], v21 offset:51200
    ds_read_b64_tr_b16 v[30:31], v21 offset:51712
    v_mul_f32 v100, v100, v44
    v_mul_f32 v101, v101, v45
    v_mul_f32 v102, v102, v46
    v_mul_f32 v103, v103, v47
    v_xor_b32 v7, v7, v8
    s_waitcnt lgkmcnt(6)
    v_mfma_f32_32x32x16_bf16 v[56:71], v[32:35], v[144:147], v[56:71]
    ds_read_b64_tr_b16 v[32:33], v21 offset:53248
    ds_read_b64_tr_b16 v[34:35], v21 offset:53760
    v_mul_f32 v48, v104, v104
    v_mul_f32 v49, v105, v105
    v_mul_f32 v50, v106, v106
    v_mul_f32 v51, v107, v107
    v_mul_f32 v52, v108, v108
    s_waitcnt lgkmcnt(6)
    v_mfma_f32_32x32x16_bf16 v[56:71], v[36:39], v[148:151], v[56:71]
    ds_read_b64_tr_b16 v[36:37], v21 offset:55296
    ds_read_b64_tr_b16 v[38:39], v21 offset:55808
    v_mul_f32 v53, v109, v109
    v_mul_f32 v54, v110, v110
    v_mul_f32 v55, v111, v111
    v_fma_f32 v48, v48, s74, v248
    v_lshlrev_b32 v7, 4, v7
    s_waitcnt lgkmcnt(6)
    v_mfma_f32_32x32x16_bf16 v[56:71], v[24:27], v[152:155], v[56:71]
    ds_read_b64_tr_b16 v[24:25], v21 offset:57344
    ds_read_b64_tr_b16 v[26:27], v21 offset:57856
    v_fma_f32 v49, v49, s74, v248
    v_fma_f32 v50, v50, s74, v248
    v_fma_f32 v51, v51, s74, v248
    v_fma_f32 v52, v52, s74, v248
    v_fma_f32 v53, v53, s74, v248
    v_lshrrev_b32 v8, 3, v1
    s_waitcnt lgkmcnt(6)
    v_mfma_f32_32x32x16_bf16 v[56:71], v[28:31], v[156:159], v[56:71]
    ds_read_b64_tr_b16 v[28:29], v21 offset:59392
    ds_read_b64_tr_b16 v[30:31], v21 offset:59904
    v_fma_f32 v54, v54, s74, v248
    v_fma_f32 v55, v55, s74, v248
    v_mul_f32 v48, v48, v104
    v_mul_f32 v49, v49, v105
    v_lshl_add_u32 v17, v8, 10, v7
    s_waitcnt lgkmcnt(6)
    v_mfma_f32_32x32x16_bf16 v[56:71], v[32:35], v[160:163], v[56:71]
    ds_read_b64_tr_b16 v[32:33], v21 offset:61440
    ds_read_b64_tr_b16 v[34:35], v21 offset:61952
    v_mul_f32 v50, v50, v106
    v_mul_f32 v51, v51, v107
    v_mul_f32 v52, v52, v108
    v_mul_f32 v53, v53, v109
    v_mul_f32 v54, v54, v110
    s_lshl_b32 s55, s83, 7
    s_waitcnt lgkmcnt(6)
    v_mfma_f32_32x32x16_bf16 v[56:71], v[36:39], v[164:167], v[56:71]
    ds_read_b64_tr_b16 v[36:37], v21 offset:63488
    ds_read_b64_tr_b16 v[38:39], v21 offset:64000
    v_mul_f32 v55, v55, v111
    v_exp_f32 v48, v48
    v_exp_f32 v49, v49
    v_exp_f32 v50, v50
    v_add_u32 v17, s55, v17
    s_waitcnt lgkmcnt(6)
    v_mfma_f32_32x32x16_bf16 v[56:71], v[24:27], v[168:171], v[56:71]
    ds_read_b64_tr_b16 v[24:25], v22 offset:0
    ds_read_b64_tr_b16 v[26:27], v22 offset:512
    v_exp_f32 v51, v51
    v_exp_f32 v52, v52
    v_exp_f32 v53, v53
    v_exp_f32 v54, v54
    v_exp_f32 v55, v55
    s_mov_b32 s28, s16
    s_and_b32 s29, s17, 0xffff
    s_mov_b32 s30, 1835008
    s_mov_b32 s31, 0x20000
    s_waitcnt lgkmcnt(6)
    v_mfma_f32_32x32x16_bf16 v[56:71], v[28:31], v[172:175], v[56:71]
    ds_read_b64_tr_b16 v[28:29], v22 offset:2048
    ds_read_b64_tr_b16 v[30:31], v22 offset:2560
    v_add_f32 v48, 1.0, v48
    v_add_f32 v49, 1.0, v49
    v_add_f32 v50, 1.0, v50
    v_add_f32 v51, 1.0, v51
    s_mov_b32 s40, s8
    s_and_b32 s41, s9, 0xffff
    s_mov_b32 s42, 524288
    s_mov_b32 s43, 0x20000
    s_waitcnt lgkmcnt(6)
    v_mfma_f32_32x32x16_bf16 v[56:71], v[32:35], v[176:179], v[56:71]
    ds_read_b64_tr_b16 v[32:33], v22 offset:4096
    ds_read_b64_tr_b16 v[34:35], v22 offset:4608
    v_add_f32 v52, 1.0, v52
    v_add_f32 v53, 1.0, v53
    v_add_f32 v54, 1.0, v54
    v_add_f32 v55, 1.0, v55
    v_rcp_f32 v48, v48
    s_waitcnt lgkmcnt(6)
    v_mfma_f32_32x32x16_bf16 v[56:71], v[36:39], v[180:183], v[56:71]
    ds_read_b64_tr_b16 v[36:37], v22 offset:6144
    ds_read_b64_tr_b16 v[38:39], v22 offset:6656
    v_rcp_f32 v49, v49
    v_rcp_f32 v50, v50
    v_rcp_f32 v51, v51
    v_rcp_f32 v52, v52
    s_waitcnt lgkmcnt(6)
    v_mfma_f32_32x32x16_bf16 v[56:71], v[24:27], v[184:187], v[56:71]
    ds_read_b64_tr_b16 v[24:25], v20 offset:32768
    ds_read_b64_tr_b16 v[26:27], v20 offset:33280
    v_rcp_f32 v53, v53
    v_rcp_f32 v54, v54
    v_rcp_f32 v55, v55
    v_mul_f32 v104, v104, v48
    v_mul_f32 v105, v105, v49
    s_cmp_eq_u32 s52, 0
    s_cselect_b32 s54, 0, 17825792
    buffer_load_dwordx2 v[250:251], v252, s[44:47], s54 offen sc1
    s_waitcnt lgkmcnt(6)
    v_mfma_f32_32x32x16_bf16 v[56:71], v[28:31], v[188:191], v[56:71]
    ds_read_b64_tr_b16 v[28:29], v20 offset:34816
    ds_read_b64_tr_b16 v[30:31], v20 offset:35328
    v_cvt_pk_bf16_f32 v148, v88, v89
    v_mul_f32 v106, v106, v50
    v_mul_f32 v107, v107, v51
    v_mul_f32 v108, v108, v52
    v_mul_f32 v109, v109, v53
    v_and_b32 v7, 27, v1
    v_cmp_eq_u32 vcc, 16, v7
    v_mov_b32 v8, 0x3f803f80
    s_nop 0
    v_cndmask_b32 v7, 0, v8, vcc
    v_mov_b32 v124, v7
    v_mov_b32 v125, v7
    s_waitcnt lgkmcnt(6)
    v_mfma_f32_32x32x16_bf16 v[56:71], v[32:35], v[192:195], v[56:71]
    ds_read_b64_tr_b16 v[32:33], v20 offset:36864
    ds_read_b64_tr_b16 v[34:35], v20 offset:37376
    v_cvt_pk_bf16_f32 v149, v90, v91
    v_mul_f32 v110, v110, v54
    v_mul_f32 v111, v111, v55
    v_mul_f32 v48, v112, v112
    v_mul_f32 v49, v113, v113
    v_mul_f32 v50, v114, v114
    v_mov_b32 v126, v7
    v_mov_b32 v127, v7
    s_waitcnt lgkmcnt(6)
    v_mfma_f32_32x32x16_bf16 v[56:71], v[36:39], v[196:199], v[56:71]
    ds_read_b64_tr_b16 v[36:37], v20 offset:38912
    ds_read_b64_tr_b16 v[38:39], v20 offset:39424
    v_mul_f32 v51, v115, v115
    v_mul_f32 v52, v116, v116
    v_mul_f32 v53, v117, v117
    v_mul_f32 v54, v118, v118
    v_mov_b32 v128, v7
    v_mov_b32 v129, v7
    s_waitcnt lgkmcnt(6)
    v_mfma_f32_32x32x16_bf16 v[56:71], v[24:27], v[200:203], v[56:71]
    ds_read_b64_tr_b16 v[24:25], v20 offset:40960
    ds_read_b64_tr_b16 v[26:27], v20 offset:41472
    v_cvt_pk_bf16_f32 v150, v92, v93
    v_mul_f32 v55, v119, v119
    v_fma_f32 v48, v48, s74, v248
    v_fma_f32 v49, v49, s74, v248
    v_fma_f32 v50, v50, s74, v248
    v_fma_f32 v51, v51, s74, v248
    v_mov_b32 v130, v7
    v_mov_b32 v131, v7
    s_waitcnt lgkmcnt(6)
    v_mfma_f32_32x32x16_bf16 v[56:71], v[28:31], v[204:207], v[56:71]
    ds_read_b64_tr_b16 v[28:29], v20 offset:43008
    ds_read_b64_tr_b16 v[30:31], v20 offset:43520
    v_fma_f32 v52, v52, s74, v248
    v_fma_f32 v53, v53, s74, v248
    v_fma_f32 v54, v54, s74, v248
    v_fma_f32 v55, v55, s74, v248
    v_mov_b32 v140, -1
    v_mov_b32 v141, -1
    s_waitcnt lgkmcnt(6)
    v_mfma_f32_32x32x16_bf16 v[56:71], v[32:35], v[208:211], v[56:71]
    ds_read_b64_tr_b16 v[32:33], v20 offset:45056
    ds_read_b64_tr_b16 v[34:35], v20 offset:45568
    v_cvt_pk_bf16_f32 v151, v94, v95
    v_mul_f32 v48, v48, v112
    v_mul_f32 v49, v49, v113
    v_mul_f32 v50, v50, v114
    v_mul_f32 v51, v51, v115
    v_mul_f32 v52, v52, v116
    v_mov_b32 v142, -1
    v_mov_b32 v143, -1
    s_waitcnt lgkmcnt(6)
    s_waitcnt lgkmcnt(4)
    s_waitcnt vmcnt(0)
    s_cmp_lg_u32 s52, 0
    s_cbranch_scc1 L_s1d3
    s_mov_b32 s56, 0
L_po4:
    v_cmp_eq_u64 vcc, s[58:59], v[250:251]
    s_nop 0
    s_cmp_eq_u64 vcc, -1
    s_cbranch_scc1 L_pod5
    s_sleep 6
    buffer_load_dwordx2 v[250:251], v252, s[44:47], 0 offen sc1
    s_waitcnt vmcnt(0)
    s_add_u32 s56, s56, 1
    s_cmp_lt_u32 s56, 40000
    s_cbranch_scc1 L_po4
L_pod5:
L_s1d3:
    v_mfma_f32_32x32x16_bf16 v[56:71], v[36:39], v[212:215], v[56:71]
    s_barrier
    v_mfma_f32_32x32x16_bf16 v[56:71], v[24:27], v[216:219], v[56:71]
    ds_read_b64_tr_b16 v[36:37], v20 offset:47104
    ds_read_b64_tr_b16 v[38:39], v20 offset:47616
    ds_read_b64_tr_b16 v[24:25], v22 offset:8192
    ds_read_b64_tr_b16 v[26:27], v22 offset:8704
    v_mul_f32 v53, v53, v117
    v_mul_f32 v54, v54, v118
    v_mul_f32 v55, v55, v119
    v_exp_f32 v48, v48
    buffer_load_dwordx4 v[120:123], v2, s[44:47], s101 offen sc1
    s_xor_b32 s54, s101, 1024
    buffer_load_dwordx4 v[132:135], v2, s[44:47], s54 offen sc1
    s_add_u32 m0, s57, 0
    s_add_u32 s54, s88, 0
    buffer_load_dwordx4 v2, s[44:47], s54 offen sc1 lds
    s_add_u32 m0, s57, 65536
    s_add_u32 s54, s88, 2097152
    buffer_load_dwordx4 v2, s[44:47], s54 offen sc1 lds
    v_mov_b32 v164, 0
    v_mov_b32 v165, 0
    s_waitcnt lgkmcnt(6)
    v_mfma_f32_32x32x16_bf16 v[56:71], v[28:31], v[220:223], v[56:71]
    ds_read_b64_tr_b16 v[28:29], v22 offset:10240
    ds_read_b64_tr_b16 v[30:31], v22 offset:10752
    v_cvt_pk_bf16_f32 v152, v96, v97
    v_exp_f32 v49, v49
    v_exp_f32 v50, v50
    v_exp_f32 v51, v51
    v_exp_f32 v52, v52
    v_exp_f32 v53, v53
    v_mov_b32 v166, 0
    v_mov_b32 v167, 0
    v_mov_b32 v168, 0
    s_waitcnt lgkmcnt(6)
    v_mfma_f32_32x32x16_bf16 v[56:71], v[32:35], v[224:227], v[56:71]
    ds_read_b64_tr_b16 v[32:33], v22 offset:12288
    ds_read_b64_tr_b16 v[34:35], v22 offset:12800
    v_cvt_pk_bf16_f32 v153, v98, v99
    v_exp_f32 v54, v54
    v_exp_f32 v55, v55
    v_add_f32 v48, 1.0, v48
    v_add_f32 v49, 1.0, v49
    v_mov_b32 v169, 0
    v_mov_b32 v170, 0
    s_waitcnt lgkmcnt(6)
    v_mfma_f32_32x32x16_bf16 v[56:71], v[36:39], v[228:231], v[56:71]
    ds_read_b64_tr_b16 v[36:37], v22 offset:14336
    ds_read_b64_tr_b16 v[38:39], v22 offset:14848
    v_add_f32 v50, 1.0, v50
    v_add_f32 v51, 1.0, v51
    v_add_f32 v52, 1.0, v52
    v_add_f32 v53, 1.0, v53
    v_add_f32 v54, 1.0, v54
    s_add_u32 m0, s57, 32768
    s_add_u32 s54, s88, 32768
    buffer_load_dwordx4 v2, s[44:47], s54 offen sc1 lds
    s_add_u32 m0, s57, 98304
    s_add_u32 s54, s88, 2129920
    buffer_load_dwordx4 v2, s[44:47], s54 offen sc1 lds
    v_mov_b32 v171, 0
    v_mov_b32 v172, 0
    s_waitcnt lgkmcnt(6)
    v_mfma_f32_32x32x16_bf16 v[56:71], v[24:27], v[232:235], v[56:71]
    v_cvt_pk_bf16_f32 v154, v100, v101
    v_add_f32 v55, 1.0, v55
    v_rcp_f32 v48, v48
    v_rcp_f32 v49, v49
    v_rcp_f32 v50, v50
    v_mov_b32 v173, 0
    v_mov_b32 v174, 0
    s_waitcnt lgkmcnt(4)
    v_mfma_f32_32x32x16_bf16 v[56:71], v[28:31], v[236:239], v[56:71]
    v_rcp_f32 v51, v51
    v_rcp_f32 v52, v52
    v_rcp_f32 v53, v53
    v_rcp_f32 v54, v54
    v_rcp_f32 v55, v55
    v_mov_b32 v175, 0
    v_mov_b32 v176, 0
    s_waitcnt lgkmcnt(2)
    v_mfma_f32_32x32x16_bf16 v[56:71], v[32:35], v[240:243], v[56:71]
    v_cvt_pk_bf16_f32 v155, v102, v103
    v_mul_f32 v112, v112, v48
    v_mul_f32 v113, v113, v49
    v_mul_f32 v114, v114, v50
    v_mul_f32 v115, v115, v51
    v_mov_b32 v177, 0
    v_mov_b32 v178, 0
    s_waitcnt lgkmcnt(0)
    v_mfma_f32_32x32x16_bf16 v[56:71], v[36:39], v[244:247], v[56:71]
    v_mul_f32 v116, v116, v52
    v_mul_f32 v117, v117, v53
    v_mul_f32 v118, v118, v54
    v_mul_f32 v119, v119, v55
    v_mov_b32 v179, 0
    s_mov_b32 s48, s20
    s_and_b32 s49, s21, 0xffff
    s_mov_b32 s50, 2097152
    s_mov_b32 s51, 0x20000
    s_branch L_attn
L_p1B:
    s_lshl_b32 s66, s61, 8
    s_sub_u32 s66, s66, 1024
    s_add_u32 s67, s66, 128
    s_lshl_b32 s68, s61, 7
    s_add_u32 s69, s68, 1536
    s_mov_b32 s70, s69
    s_lshl1_add_u32 s80, s4, s65
    s_add_u32 s80, s80, 0
    s_lshl1_add_u32 s81, s4, s65
    s_add_u32 s81, s81, 65536
    s_mul_i32 s82, s4, 3072
    s_add_u32 s82, s82, s66
    s_mul_i32 s83, s4, 3072
    s_add_u32 s83, s83, s67
    s_mul_i32 s84, s4, 3072
    s_add_u32 s84, s84, s68
    s_waitcnt lgkmcnt(0)
    s_load_dwordx2 s[8:9], s[0:1], 16
    s_load_dwordx2 s[16:17], s[0:1], 48
    s_load_dwordx2 s[24:25], s[0:1], 80
    s_load_dwordx4 s[20:23], s[0:1], 64
    s_add_u32 m0, s57, 0
    s_nop 0
    buffer_load_dwordx4 v13, s[28:31], s80 offen lds
    s_add_u32 m0, s57, 8192
    s_nop 0
    buffer_load_dwordx4 v13, s[28:31], s81 offen lds
    s_add_u32 m0, s57, 65536
    s_nop 0
    buffer_load_dwordx4 v14, s[40:43], s82 offen lds
    s_add_u32 m0, s57, 73728
    s_nop 0
    buffer_load_dwordx4 v14, s[40:43], s83 offen lds
    s_add_u32 m0, s57, 81920
    s_nop 0
    buffer_load_dwordx4 v14, s[40:43], s84 offen lds
    buffer_load_dwordx4 v[44:47], v2, s[48:51], 0 offen
    s_waitcnt lgkmcnt(0)
    s_mov_b32 s48, s22
    s_and_b32 s49, s23, 0xffff
    s_mov_b32 s50, 256
    s_mov_b32 s51, 0x20000
    v_and_b32 v7, 31, v1
    v_lshrrev_b32 v8, 5, v1
    v_bfe_u32 v9, v1, 1, 3
    v_xor_b32 v9, v9, v8
    v_lshlrev_b32 v9, 4, v9
    s_lshl_b32 s53, s3, 5
    v_add_u32 v7, s53, v7
    v_lshl_add_u32 v16, v7, 7, v9
    v_xor_b32 v17, 32, v16
    v_xor_b32 v18, 64, v16
    v_xor_b32 v19, 96, v16
    v_lshlrev_b32 v9, 10, v8
    v_bfe_u32 v6, v1, 2, 2
    v_lshl_add_u32 v9, v6, 7, v9
    v_bfe_u32 v6, v1, 3, 1
    v_xor_b32 v6, s63, v6
    v_lshl_add_u32 v9, v6, 6, v9
    v_bfe_u32 v6, v1, 4, 1
    v_lshl_add_u32 v9, v6, 5, v9
    v_and_b32 v6, 3, v1
    v_lshl_add_u32 v20, v6, 3, v9
    v_add_u32 v21, 65536, v20
    v_add_u32 v22, 131072, v20
    v_mov_b32 v248, 0xc0135761
    v_mov_b32 v249, 0xc0135761
    v_bfe_u32 v7, v1, 4, 1
    v_lshlrev_b32 v7, 16, v7
    v_lshl_add_u32 v7, v8, 8, v7
    v_and_b32 v8, 15, v1
    v_lshl_add_u32 v23, v8, 4, v7
    v_mov_b32 v254, 0xdddddddd
    s_lshl1_add_u32 s53, s61, s63
    s_lshl_b32 s71, s53, 7
    s_add_u32 s71, s71, s64
    s_lshl_b32 s71, s71, 10
    s_lshl4_add_u32 s94, s61, s60
    s_lshl_b32 s94, s94, 7
    s_add_u32 s94, s94, 16842752
    s_cmp_eq_u32 s52, 0
    s_cselect_b32 s94, s94, 17825792
    s_lshl_b32 s90, s64, 5
    s_add_u32 s90, s90, s53
    s_lshl_b32 s90, s90, 7
    s_add_u32 s90, s90, 16908288
    s_lshl4_add_u32 s54, s60, s61
    s_lshl3_add_u32 s79, s54, s52
    s_lshl_b32 s79, s79, 10
    s_lshl_b32 s78, s54, 7
    s_lshl2_add_u32 s78, s52, s78
    s_add_u32 s78, s78, 16777216
    s_mul_i32 s54, s64, 144
    s_add_u32 s95, s54, s53
    s_lshl_b32 s95, s95, 10
    s_add_u32 s95, s95, 6291456
    s_lshl1_add_u32 s54, s63, s54
    s_lshr_b32 s76, s67, 5
    s_add_u32 s76, s76, s54
    s_lshl_b32 s76, s76, 10
    s_add_u32 s76, s76, 6324224
    s_lshr_b32 s77, s69, 5
    s_add_u32 s77, s77, s54
    s_lshl_b32 s77, s77, 10
    s_add_u32 s77, s77, 6324224
    s_cmp_lt_u32 s61, 8
    s_cselect_b32 s72, 0x3eb8aa3b, 1.0
    s_mov_b32 s76, 17825792
    s_sub_u32 s73, s61, 12
    s_lshl2_add_u32 s73, s73, s63
    s_lshl_b32 s73, s73, 17
    s_lshl_b32 s54, s64, 10
    s_add_u32 s73, s73, s54
    s_add_u32 s73, s73, 4194304
    s_mov_b32 s74, 0xbdd2d3e8
    s_mov_b32 s75, s74
    s_and_b32 s53, s2, 7
    s_bfe_u32 s54, s2, 131075
    s_lshl2_add_u32 s80, s53, s54
    s_lshl_b32 s82, s80, 1
    s_lshr_b32 s83, s2, 5
    s_lshl1_add_u32 s81, s3, s63
    s_lshl3_add_u32 s81, s83, s81
    s_lshl_b32 s53, s80, 16
    s_add_u32 s88, s53, s57
    s_add_u32 s88, s88, 2097152
    s_lshl_b32 s101, s81, 10
    s_add_u32 s101, s101, s53
    s_mul_i32 s97, s81, 144
    s_add_u32 s97, s97, s80
    s_lshl_b32 s97, s97, 10
    s_add_u32 s97, s97, 6291456
    s_lshl_b32 s99, s81, 9
    s_add_u32 s99, s99, 16777216
    s_add_u32 s54, s82, s63
    s_lshl_b32 s100, s54, 9
    s_add_u32 s100, s100, 16777216
    s_lshl_b32 s96, s54, 15
    s_lshl_b32 s55, s83, 7
    s_add_u32 s96, s96, s55
    s_lshl_b32 s55, s3, 5
    s_add_u32 s96, s96, s55
    s_mul_i32 s86, s54, 144
    s_lshl3_add_u32 s98, s3, s86
    s_lshl_b32 s98, s98, 10
    s_add_u32 s98, s98, 6291456
    s_xor_b32 s54, s54, 1
    s_mul_i32 s87, s54, 144
    s_mul_i32 s55, s52, 14
    s_add_u32 s55, s55, 6176
    s_add_u32 s86, s86, s55
    s_add_u32 s87, s87, s55
    s_lshl_b32 s86, s86, 10
    s_lshl_b32 s87, s87, 10
    s_mul_i32 s85, s52, 229376
    s_lshl_b32 s84, s52, 12
    s_add_u32 s84, s84, 131072
    s_lshr_b32 s53, s52, 1
    s_lshl_b32 s53, s53, 15
    s_and_b32 s91, s52, 1
    s_lshl_b32 s91, s91, 13
    s_add_u32 s91, s91, s53
    s_mul_i32 s62, s63, 6144
    s_lshl_b32 s53, s3, 15
    s_add_u32 s62, s62, s53
    s_add_u32 s62, s62, 16384
    s_lshl_b32 s89, s63, 15
    s_mov_b32 s92, 0xffff
    s_mov_b32 s93, 0xffff
    v_and_b32 v6, 15, v1
    s_lshr_b32 s53, s80, 2
    s_lshl_b32 s53, s53, 4
    s_add_u32 s54, s53, 128
    v_add_u32 v7, s54, v6
    s_lshr_b32 s54, s80, 3
    s_lshl_b32 s54, s54, 4
    s_add_u32 s54, s54, 192
    v_add_u32 v8, s54, v6
    v_cmp_lt_u32 vcc, 15, v1
    s_nop 1
    v_cndmask_b32 v7, v7, v8, vcc
    s_lshl1_add_u32 s53, s83, s53
    v_and_b32 v6, 1, v1
    v_add_u32 v8, s53, v6
    v_cmp_lt_u32 vcc, 31, v1
    s_nop 1
    v_cndmask_b32 v7, v7, v8, vcc
    v_lshlrev_b32 v7, 7, v7
    v_add_u32 v252, 16842752, v7
    v_and_b32 v6, 7, v1
    v_min_u32 v7, 6, v6
    s_mul_i32 s53, s52, 7
    v_add_u32 v7, s53, v7
    v_subrev_u32 v9, 24, v7
    v_cmp_lt_u32 vcc, 23, v7
    s_nop 1
    v_cndmask_b32 v7, v7, v9, vcc
    v_bfe_u32 v8, v1, 3, 1
    v_add_u32 v8, s82, v8
    v_lshl_add_u32 v7, v8, 5, v7
    s_add_u32 s55, s82, s63
    s_lshl_b32 s53, s55, 5
    s_lshl3_add_u32 s53, s3, s53
    v_add_u32 v8, s53, v6
    v_cmp_lt_u32 vcc, 15, v1
    s_nop 1
    v_cndmask_b32 v7, v7, v8, vcc
    v_add_u32 v7, 512, v7
    v_and_b32 v6, 3, v1
    v_lshlrev_b32 v6, 4, v6
    s_and_b32 s53, s81, 3
    s_lshl_b32 s53, s53, 6
    s_lshr_b32 s54, s81, 2
    s_add_u32 s53, s53, s54
    v_add_u32 v8, s53, v6
    v_cmp_lt_u32 vcc, 23, v1
    s_nop 1
    v_cndmask_b32 v7, v7, v8, vcc
    s_and_b32 s53, s55, 3
    s_lshl_b32 s53, s53, 6
    s_lshr_b32 s54, s55, 2
    s_add_u32 s53, s53, s54
    v_add_u32 v8, s53, v6
    v_cmp_lt_u32 vcc, 27, v1
    s_nop 1
    v_cndmask_b32 v7, v7, v8, vcc
    s_lshl_b32 s53, s81, 5
    s_add_u32 s53, s53, s80
    s_add_u32 s53, s53, 512
    v_mov_b32 v8, s53
    v_cmp_lt_u32 vcc, 31, v1
    s_nop 1
    v_cndmask_b32 v7, v7, v8, vcc
    v_lshlrev_b32 v7, 7, v7
    v_add_u32 v253, 16842752, v7
    s_lshl1_add_u32 s53, s5, s65
    s_add_u32 m0, s57, 16384
    s_add_u32 s53, s53, 0
    buffer_load_dwordx4 v13, s[28:31], s53 offen lds
    s_lshl1_add_u32 s53, s5, s65
    s_add_u32 m0, s57, 24576
    s_add_u32 s53, s53, 65536
    buffer_load_dwordx4 v13, s[28:31], s53 offen lds
    s_mul_i32 s53, s5, 3072
    s_add_u32 m0, s57, 90112
    s_add_u32 s53, s53, s66
    buffer_load_dwordx4 v14, s[40:43], s53 offen lds
    s_mul_i32 s53, s5, 3072
    s_add_u32 m0, s57, 98304
    s_add_u32 s53, s53, s67
    buffer_load_dwordx4 v14, s[40:43], s53 offen lds
    s_mul_i32 s53, s5, 3072
    s_add_u32 m0, s57, 106496
    s_add_u32 s53, s53, s68
    buffer_load_dwordx4 v14, s[40:43], s53 offen lds
    s_waitcnt vmcnt(6)
    s_barrier
    ds_read_b64_tr_b16 v[24:25], v21 offset:0
    ds_read_b64_tr_b16 v[26:27], v21 offset:512
    ds_read_b128 v[120:123], v16 offset:0
    ds_read_b64_tr_b16 v[28:29], v21 offset:2048
    ds_read_b64_tr_b16 v[30:31], v21 offset:2560
    ds_read_b128 v[124:127], v17 offset:0
    ds_read_b64_tr_b16 v[32:33], v21 offset:4096
    ds_read_b64_tr_b16 v[34:35], v21 offset:4608
    ds_read_b128 v[128:131], v18 offset:0
    ds_read_b64_tr_b16 v[36:37], v21 offset:6144
    ds_read_b64_tr_b16 v[38:39], v21 offset:6656
    ds_read_b128 v[132:135], v19 offset:0
    s_waitcnt lgkmcnt(9)
    v_mfma_f32_32x32x16_bf16 v[56:71], v[120:123], v[24:27], 0
    ds_read_b64_tr_b16 v[24:25], v21 offset:8192
    ds_read_b64_tr_b16 v[26:27], v21 offset:8704
    s_lshl1_add_u32 s53, s6, s65
    s_add_u32 m0, s57, 32768
    s_add_u32 s53, s53, 0
    buffer_load_dwordx4 v13, s[28:31], s53 offen lds
    s_waitcnt lgkmcnt(8)
    v_mfma_f32_32x32x16_bf16 v[56:71], v[124:127], v[28:31], v[56:71]
    ds_read_b64_tr_b16 v[28:29], v21 offset:10240
    ds_read_b64_tr_b16 v[30:31], v21 offset:10752
    s_waitcnt lgkmcnt(7)
    v_mfma_f32_32x32x16_bf16 v[56:71], v[128:131], v[32:35], v[56:71]
    ds_read_b64_tr_b16 v[32:33], v21 offset:12288
    ds_read_b64_tr_b16 v[34:35], v21 offset:12800
    s_lshl1_add_u32 s53, s6, s65
    s_add_u32 m0, s57, 40960
    s_add_u32 s53, s53, 65536
    buffer_load_dwordx4 v13, s[28:31], s53 offen lds
    s_waitcnt lgkmcnt(6)
    v_mfma_f32_32x32x16_bf16 v[56:71], v[132:135], v[36:39], v[56:71]
    ds_read_b64_tr_b16 v[36:37], v21 offset:14336
    ds_read_b64_tr_b16 v[38:39], v21 offset:14848
    s_waitcnt lgkmcnt(6)
    v_mfma_f32_32x32x16_bf16 v[72:87], v[120:123], v[24:27], 0
    ds_read_b64_tr_b16 v[24:25], v21 offset:16384
    ds_read_b64_tr_b16 v[26:27], v21 offset:16896
    s_mul_i32 s53, s6, 3072
    s_add_u32 m0, s57, 114688
    s_add_u32 s53, s53, s66
    buffer_load_dwordx4 v14, s[40:43], s53 offen lds
    s_waitcnt lgkmcnt(6)
    v_mfma_f32_32x32x16_bf16 v[72:87], v[124:127], v[28:31], v[72:87]
    ds_read_b64_tr_b16 v[28:29], v21 offset:18432
    ds_read_b64_tr_b16 v[30:31], v21 offset:18944
    s_waitcnt lgkmcnt(6)
    v_mfma_f32_32x32x16_bf16 v[72:87], v[128:131], v[32:35], v[72:87]
    ds_read_b64_tr_b16 v[32:33], v21 offset:20480
    ds_read_b64_tr_b16 v[34:35], v21 offset:20992
    s_mul_i32 s53, s6, 3072
    s_add_u32 m0, s57, 122880
    s_add_u32 s53, s53, s67
    buffer_load_dwordx4 v14, s[40:43], s53 offen lds
    s_waitcnt lgkmcnt(6)
    v_mfma_f32_32x32x16_bf16 v[72:87], v[132:135], v[36:39], v[72:87]
    ds_read_b64_tr_b16 v[36:37], v21 offset:22528
    ds_read_b64_tr_b16 v[38:39], v21 offset:23040
    s_waitcnt lgkmcnt(6)
    v_mfma_f32_32x32x16_bf16 v[88:103], v[24:27], v[120:123], 0
    s_mul_i32 s53, s6, 3072
    s_add_u32 m0, s57, 131072
    s_add_u32 s53, s53, s68
    buffer_load_dwordx4 v14, s[40:43], s53 offen lds
    s_waitcnt lgkmcnt(4)
    v_mfma_f32_32x32x16_bf16 v[88:103], v[28:31], v[124:127], v[88:103]
    s_waitcnt lgkmcnt(2)
    v_mfma_f32_32x32x16_bf16 v[88:103], v[32:35], v[128:131], v[88:103]
    s_lshl1_add_u32 s53, s7, s65
    s_add_u32 m0, s57, 49152
    s_add_u32 s53, s53, 0
    buffer_load_dwordx4 v13, s[28:31], s53 offen lds
    s_waitcnt lgkmcnt(0)
    s_waitcnt vmcnt(3)
    v_mfma_f32_32x32x16_bf16 v[88:103], v[36:39], v[132:135], v[88:103]
    s_barrier
    ds_read_b64_tr_b16 v[24:25], v21 offset:24576
    ds_read_b64_tr_b16 v[26:27], v21 offset:25088
    ds_read_b128 v[136:139], v16 offset:16384
    ds_read_b64_tr_b16 v[28:29], v21 offset:26624
    ds_read_b64_tr_b16 v[30:31], v21 offset:27136
    ds_read_b128 v[140:143], v17 offset:16384
    ds_read_b64_tr_b16 v[32:33], v21 offset:28672
    ds_read_b64_tr_b16 v[34:35], v21 offset:29184
    ds_read_b128 v[144:147], v18 offset:16384
    ds_read_b64_tr_b16 v[36:37], v21 offset:30720
    ds_read_b64_tr_b16 v[38:39], v21 offset:31232
    ds_read_b128 v[148:151], v19 offset:16384
    s_waitcnt lgkmcnt(9)
    v_mfma_f32_32x32x16_bf16 v[56:71], v[136:139], v[24:27], v[56:71]
    ds_read_b64_tr_b16 v[24:25], v21 offset:32768
    ds_read_b64_tr_b16 v[26:27], v21 offset:33280
    s_lshl1_add_u32 s53, s7, s65
    s_add_u32 m0, s57, 57344
    s_add_u32 s53, s53, 65536
    buffer_load_dwordx4 v13, s[28:31], s53 offen lds
    s_waitcnt lgkmcnt(8)
    v_mfma_f32_32x32x16_bf16 v[56:71], v[140:143], v[28:31], v[56:71]
    ds_read_b64_tr_b16 v[28:29], v21 offset:34816
    ds_read_b64_tr_b16 v[30:31], v21 offset:35328
    s_waitcnt lgkmcnt(7)
    v_mfma_f32_32x32x16_bf16 v[56:71], v[144:147], v[32:35], v[56:71]
    ds_read_b64_tr_b16 v[32:33], v21 offset:36864
    ds_read_b64_tr_b16 v[34:35], v21 offset:37376
    s_mul_i32 s53, s7, 3072
    s_add_u32 m0, s57, 139264
    s_add_u32 s53, s53, s66
    buffer_load_dwordx4 v14, s[40:43], s53 offen lds
    s_waitcnt lgkmcnt(6)
    v_mfma_f32_32x32x16_bf16 v[56:71], v[148:151], v[36:39], v[56:71]
    ds_read_b64_tr_b16 v[36:37], v21 offset:38912
    ds_read_b64_tr_b16 v[38:39], v21 offset:39424
    s_waitcnt lgkmcnt(6)
    v_mfma_f32_32x32x16_bf16 v[72:87], v[136:139], v[24:27], v[72:87]
    ds_read_b64_tr_b16 v[24:25], v21 offset:40960
    ds_read_b64_tr_b16 v[26:27], v21 offset:41472
    s_mul_i32 s53, s7, 3072
    s_add_u32 m0, s57, 147456
    s_add_u32 s53, s53, s67
    buffer_load_dwordx4 v14, s[40:43], s53 offen lds
    s_waitcnt lgkmcnt(6)
    v_mfma_f32_32x32x16_bf16 v[72:87], v[140:143], v[28:31], v[72:87]
    ds_read_b64_tr_b16 v[28:29], v21 offset:43008
    ds_read_b64_tr_b16 v[30:31], v21 offset:43520
    s_waitcnt lgkmcnt(6)
    v_mfma_f32_32x32x16_bf16 v[72:87], v[144:147], v[32:35], v[72:87]
    ds_read_b64_tr_b16 v[32:33], v21 offset:45056
    ds_read_b64_tr_b16 v[34:35], v21 offset:45568
    s_mul_i32 s53, s7, 3072
    s_add_u32 m0, s57, 155648
    s_add_u32 s53, s53, s68
    buffer_load_dwordx4 v14, s[40:43], s53 offen lds
    s_waitcnt lgkmcnt(6)
    v_mfma_f32_32x32x16_bf16 v[72:87], v[148:151], v[36:39], v[72:87]
    ds_read_b64_tr_b16 v[36:37], v21 offset:47104
    ds_read_b64_tr_b16 v[38:39], v21 offset:47616
    s_waitcnt lgkmcnt(6)
    v_mfma_f32_32x32x16_bf16 v[88:103], v[24:27], v[136:139], v[88:103]
    ds_read_b64_tr_b16 v[24:25], v21 offset:49152
    ds_read_b64_tr_b16 v[26:27], v21 offset:49664
    ds_read_b128 v[152:155], v16 offset:32768
    s_lshl1_add_u32 s53, s12, s65
    s_add_u32 m0, s57, 0
    s_add_u32 s53, s53, 0
    buffer_load_dwordx4 v13, s[28:31], s53 offen lds
    s_waitcnt lgkmcnt(7)
    v_mfma_f32_32x32x16_bf16 v[88:103], v[28:31], v[140:143], v[88:103]
    ds_read_b64_tr_b16 v[28:29], v21 offset:51200
    ds_read_b64_tr_b16 v[30:31], v21 offset:51712
    ds_read_b128 v[156:159], v17 offset:32768
    s_waitcnt lgkmcnt(8)
    v_mfma_f32_32x32x16_bf16 v[88:103], v[32:35], v[144:147], v[88:103]
    ds_read_b64_tr_b16 v[32:33], v21 offset:53248
    ds_read_b64_tr_b16 v[34:35], v21 offset:53760
    ds_read_b128 v[160:163], v18 offset:32768
    s_lshl1_add_u32 s53, s12, s65
    s_add_u32 m0, s57, 8192
    s_add_u32 s53, s53, 65536
    buffer_load_dwordx4 v13, s[28:31], s53 offen lds
    s_waitcnt lgkmcnt(9)
    s_waitcnt lgkmcnt(6)
    s_waitcnt vmcnt(4)
    v_mfma_f32_32x32x16_bf16 v[88:103], v[36:39], v[148:151], v[88:103]
    s_barrier
    v_mfma_f32_32x32x16_bf16 v[56:71], v[152:155], v[24:27], v[56:71]
    ds_read_b64_tr_b16 v[36:37], v21 offset:55296
    ds_read_b64_tr_b16 v[38:39], v21 offset:55808
    ds_read_b128 v[164:167], v19 offset:32768
    ds_read_b64_tr_b16 v[24:25], v21 offset:57344
    ds_read_b64_tr_b16 v[26:27], v21 offset:57856
    s_mul_i32 s53, s12, 3072
    s_add_u32 m0, s57, 65536
    s_add_u32 s53, s53, s66
    buffer_load_dwordx4 v14, s[40:43], s53 offen lds
    s_waitcnt lgkmcnt(8)
    v_mfma_f32_32x32x16_bf16 v[56:71], v[156:159], v[28:31], v[56:71]
    ds_read_b64_tr_b16 v[28:29], v21 offset:59392
    ds_read_b64_tr_b16 v[30:31], v21 offset:59904
    s_waitcnt lgkmcnt(7)
    v_mfma_f32_32x32x16_bf16 v[56:71], v[160:163], v[32:35], v[56:71]
    ds_read_b64_tr_b16 v[32:33], v21 offset:61440
    ds_read_b64_tr_b16 v[34:35], v21 offset:61952
    s_mul_i32 s53, s12, 3072
    s_add_u32 m0, s57, 73728
    s_add_u32 s53, s53, s67
    buffer_load_dwordx4 v14, s[40:43], s53 offen lds
    buffer_load_dwordx4 v[40:43], v2, s[28:31], s79 offen
    s_waitcnt lgkmcnt(6)
    v_mfma_f32_32x32x16_bf16 v[56:71], v[164:167], v[36:39], v[56:71]
    ds_read_b64_tr_b16 v[36:37], v21 offset:63488
    ds_read_b64_tr_b16 v[38:39], v21 offset:64000
    s_waitcnt lgkmcnt(6)
    v_mfma_f32_32x32x16_bf16 v[72:87], v[152:155], v[24:27], v[72:87]
    ds_read_b64_tr_b16 v[24:25], v22 offset:0
    ds_read_b64_tr_b16 v[26:27], v22 offset:512
    s_mul_i32 s53, s12, 3072
    s_add_u32 m0, s57, 81920
    s_add_u32 s53, s53, s68
    buffer_load_dwordx4 v14, s[40:43], s53 offen lds
    s_waitcnt lgkmcnt(6)
    v_mfma_f32_32x32x16_bf16 v[72:87], v[156:159], v[28:31], v[72:87]
    ds_read_b64_tr_b16 v[28:29], v22 offset:2048
    ds_read_b64_tr_b16 v[30:31], v22 offset:2560
    s_waitcnt lgkmcnt(6)
    v_mfma_f32_32x32x16_bf16 v[72:87], v[160:163], v[32:35], v[72:87]
    ds_read_b64_tr_b16 v[32:33], v22 offset:4096
    ds_read_b64_tr_b16 v[34:35], v22 offset:4608
    s_lshl1_add_u32 s53, s13, s65
    s_add_u32 m0, s57, 16384
    s_add_u32 s53, s53, 0
    buffer_load_dwordx4 v13, s[28:31], s53 offen lds
    s_waitcnt lgkmcnt(6)
    v_mfma_f32_32x32x16_bf16 v[72:87], v[164:167], v[36:39], v[72:87]
    ds_read_b64_tr_b16 v[36:37], v22 offset:6144
    ds_read_b64_tr_b16 v[38:39], v22 offset:6656
    s_waitcnt lgkmcnt(6)
    v_mfma_f32_32x32x16_bf16 v[88:103], v[24:27], v[152:155], v[88:103]
    ds_read_b64_tr_b16 v[24:25], v22 offset:8192
    ds_read_b64_tr_b16 v[26:27], v22 offset:8704
    ds_read_b128 v[168:171], v16 offset:49152
    s_lshl1_add_u32 s53, s13, s65
    s_add_u32 m0, s57, 24576
    s_add_u32 s53, s53, 65536
    buffer_load_dwordx4 v13, s[28:31], s53 offen lds
    s_waitcnt lgkmcnt(7)
    v_mfma_f32_32x32x16_bf16 v[88:103], v[28:31], v[156:159], v[88:103]
    ds_read_b64_tr_b16 v[28:29], v22 offset:10240
    ds_read_b64_tr_b16 v[30:31], v22 offset:10752
    ds_read_b128 v[172:175], v17 offset:49152
    s_waitcnt lgkmcnt(8)
    v_mfma_f32_32x32x16_bf16 v[88:103], v[32:35], v[160:163], v[88:103]
    ds_read_b64_tr_b16 v[32:33], v22 offset:12288
    ds_read_b64_tr_b16 v[34:35], v22 offset:12800
    ds_read_b128 v[176:179], v18 offset:49152
    s_mul_i32 s53, s13, 3072
    s_add_u32 m0, s57, 90112
    s_add_u32 s53, s53, s66
    buffer_load_dwordx4 v14, s[40:43], s53 offen lds
    s_waitcnt lgkmcnt(9)
    s_waitcnt lgkmcnt(6)
    s_waitcnt vmcnt(6)
    v_mfma_f32_32x32x16_bf16 v[88:103], v[36:39], v[164:167], v[88:103]
    s_barrier
    v_mfma_f32_32x32x16_bf16 v[56:71], v[168:171], v[24:27], v[56:71]
    ds_read_b64_tr_b16 v[36:37], v22 offset:14336
    ds_read_b64_tr_b16 v[38:39], v22 offset:14848
    ds_read_b128 v[180:183], v19 offset:49152
    ds_read_b64_tr_b16 v[24:25], v22 offset:16384
    ds_read_b64_tr_b16 v[26:27], v22 offset:16896
    s_mul_i32 s53, s13, 3072
    s_add_u32 m0, s57, 98304
    s_add_u32 s53, s53, s67
    buffer_load_dwordx4 v14, s[40:43], s53 offen lds
    s_waitcnt lgkmcnt(8)
    v_mfma_f32_32x32x16_bf16 v[56:71], v[172:175], v[28:31], v[56:71]
    ds_read_b64_tr_b16 v[28:29], v22 offset:18432
    ds_read_b64_tr_b16 v[30:31], v22 offset:18944
    s_waitcnt lgkmcnt(7)
    v_mfma_f32_32x32x16_bf16 v[56:71], v[176:179], v[32:35], v[56:71]
    ds_read_b64_tr_b16 v[32:33], v22 offset:20480
    ds_read_b64_tr_b16 v[34:35], v22 offset:20992
    s_mul_i32 s53, s13, 3072
    s_add_u32 m0, s57, 106496
    s_add_u32 s53, s53, s68
    buffer_load_dwordx4 v14, s[40:43], s53 offen lds
    s_waitcnt lgkmcnt(6)
    v_mfma_f32_32x32x16_bf16 v[56:71], v[180:183], v[36:39], v[56:71]
    ds_read_b64_tr_b16 v[36:37], v22 offset:22528
    ds_read_b64_tr_b16 v[38:39], v22 offset:23040
    s_waitcnt lgkmcnt(6)
    v_mfma_f32_32x32x16_bf16 v[72:87], v[168:171], v[24:27], v[72:87]
    ds_read_b64_tr_b16 v[24:25], v22 offset:24576
    ds_read_b64_tr_b16 v[26:27], v22 offset:25088
    s_lshl1_add_u32 s53, s14, s65
    s_add_u32 m0, s57, 32768
    s_add_u32 s53, s53, 0
    buffer_load_dwordx4 v13, s[28:31], s53 offen lds
    s_waitcnt lgkmcnt(6)
    v_mfma_f32_32x32x16_bf16 v[72:87], v[172:175], v[28:31], v[72:87]
    ds_read_b64_tr_b16 v[28:29], v22 offset:26624
    ds_read_b64_tr_b16 v[30:31], v22 offset:27136
    s_waitcnt lgkmcnt(6)
    v_mfma_f32_32x32x16_bf16 v[72:87], v[176:179], v[32:35], v[72:87]
    ds_read_b64_tr_b16 v[32:33], v22 offset:28672
    ds_read_b64_tr_b16 v[34:35], v22 offset:29184
    s_lshl1_add_u32 s53, s14, s65
    s_add_u32 m0, s57, 40960
    s_add_u32 s53, s53, 65536
    buffer_load_dwordx4 v13, s[28:31], s53 offen lds
    s_waitcnt lgkmcnt(6)
    v_mfma_f32_32x32x16_bf16 v[72:87], v[180:183], v[36:39], v[72:87]
    ds_read_b64_tr_b16 v[36:37], v22 offset:30720
    ds_read_b64_tr_b16 v[38:39], v22 offset:31232
    s_waitcnt lgkmcnt(6)
    v_mfma_f32_32x32x16_bf16 v[88:103], v[24:27], v[168:171], v[88:103]
    ds_read_b64_tr_b16 v[24:25], v21 offset:0
    ds_read_b64_tr_b16 v[26:27], v21 offset:512
    ds_read_b128 v[184:187], v16 offset:0
    s_mul_i32 s53, s14, 3072
    s_add_u32 m0, s57, 114688
    s_add_u32 s53, s53, s66
    buffer_load_dwordx4 v14, s[40:43], s53 offen lds
    s_waitcnt lgkmcnt(7)
    v_mfma_f32_32x32x16_bf16 v[88:103], v[28:31], v[172:175], v[88:103]
    ds_read_b64_tr_b16 v[28:29], v21 offset:2048
    ds_read_b64_tr_b16 v[30:31], v21 offset:2560
    ds_read_b128 v[188:191], v17 offset:0
    s_waitcnt lgkmcnt(8)
    v_mfma_f32_32x32x16_bf16 v[88:103], v[32:35], v[176:179], v[88:103]
    ds_read_b64_tr_b16 v[32:33], v21 offset:4096
    ds_read_b64_tr_b16 v[34:35], v21 offset:4608
    ds_read_b128 v[192:195], v18 offset:0
    s_mul_i32 s53, s14, 3072
    s_add_u32 m0, s57, 122880
    s_add_u32 s53, s53, s67
    buffer_load_dwordx4 v14, s[40:43], s53 offen lds
    s_waitcnt lgkmcnt(9)
    s_waitcnt lgkmcnt(6)
    s_waitcnt vmcnt(6)
    v_mfma_f32_32x32x16_bf16 v[88:103], v[36:39], v[180:183], v[88:103]
    s_barrier
    v_mfma_f32_32x32x16_bf16 v[56:71], v[184:187], v[24:27], v[56:71]
    ds_read_b64_tr_b16 v[36:37], v21 offset:6144
    ds_read_b64_tr_b16 v[38:39], v21 offset:6656
    ds_read_b128 v[196:199], v19 offset:0
    ds_read_b64_tr_b16 v[24:25], v21 offset:8192
    ds_read_b64_tr_b16 v[26:27], v21 offset:8704
    s_mul_i32 s53, s14, 3072
    s_add_u32 m0, s57, 131072
    s_add_u32 s53, s53, s68
    buffer_load_dwordx4 v14, s[40:43], s53 offen lds
    s_waitcnt lgkmcnt(8)
    v_mfma_f32_32x32x16_bf16 v[56:71], v[188:191], v[28:31], v[56:71]
    ds_read_b64_tr_b16 v[28:29], v21 offset:10240
    ds_read_b64_tr_b16 v[30:31], v21 offset:10752
    s_waitcnt lgkmcnt(7)
    v_mfma_f32_32x32x16_bf16 v[56:71], v[192:195], v[32:35], v[56:71]
    ds_read_b64_tr_b16 v[32:33], v21 offset:12288
    ds_read_b64_tr_b16 v[34:35], v21 offset:12800
    s_lshl1_add_u32 s53, s15, s65
    s_add_u32 m0, s57, 49152
    s_add_u32 s53, s53, 0
    buffer_load_dwordx4 v13, s[28:31], s53 offen lds
    s_waitcnt lgkmcnt(6)
    v_mfma_f32_32x32x16_bf16 v[56:71], v[196:199], v[36:39], v[56:71]
    ds_read_b64_tr_b16 v[36:37], v21 offset:14336
    ds_read_b64_tr_b16 v[38:39], v21 offset:14848
    s_waitcnt lgkmcnt(6)
    v_mfma_f32_32x32x16_bf16 v[72:87], v[184:187], v[24:27], v[72:87]
    ds_read_b64_tr_b16 v[24:25], v21 offset:16384
    ds_read_b64_tr_b16 v[26:27], v21 offset:16896
    s_lshl1_add_u32 s53, s15, s65
    s_add_u32 m0, s57, 57344
    s_add_u32 s53, s53, 65536
    buffer_load_dwordx4 v13, s[28:31], s53 offen lds
    s_waitcnt lgkmcnt(6)
    v_mfma_f32_32x32x16_bf16 v[72:87], v[188:191], v[28:31], v[72:87]
    ds_read_b64_tr_b16 v[28:29], v21 offset:18432
    ds_read_b64_tr_b16 v[30:31], v21 offset:18944
    s_waitcnt lgkmcnt(6)
    v_mfma_f32_32x32x16_bf16 v[72:87], v[192:195], v[32:35], v[72:87]
    ds_read_b64_tr_b16 v[32:33], v21 offset:20480
    ds_read_b64_tr_b16 v[34:35], v21 offset:20992
    s_mul_i32 s53, s15, 3072
    s_add_u32 m0, s57, 139264
    s_add_u32 s53, s53, s66
    buffer_load_dwordx4 v14, s[40:43], s53 offen lds
    s_waitcnt lgkmcnt(6)
    v_mfma_f32_32x32x16_bf16 v[72:87], v[196:199], v[36:39], v[72:87]
    ds_read_b64_tr_b16 v[36:37], v21 offset:22528
    ds_read_b64_tr_b16 v[38:39], v21 offset:23040
    s_waitcnt lgkmcnt(6)
    v_mfma_f32_32x32x16_bf16 v[88:103], v[24:27], v[184:187], v[88:103]
    ds_read_b64_tr_b16 v[24:25], v21 offset:24576
    ds_read_b64_tr_b16 v[26:27], v21 offset:25088
    ds_read_b128 v[200:203], v16 offset:16384
    s_mul_i32 s53, s15, 3072
    s_add_u32 m0, s57, 147456
    s_add_u32 s53, s53, s67
    buffer_load_dwordx4 v14, s[40:43], s53 offen lds
    s_waitcnt lgkmcnt(7)
    v_mfma_f32_32x32x16_bf16 v[88:103], v[28:31], v[188:191], v[88:103]
    ds_read_b64_tr_b16 v[28:29], v21 offset:26624
    ds_read_b64_tr_b16 v[30:31], v21 offset:27136
    ds_read_b128 v[204:207], v17 offset:16384
    s_waitcnt lgkmcnt(8)
    v_mfma_f32_32x32x16_bf16 v[88:103], v[32:35], v[192:195], v[88:103]
    ds_read_b64_tr_b16 v[32:33], v21 offset:28672
    ds_read_b64_tr_b16 v[34:35], v21 offset:29184
    ds_read_b128 v[208:211], v18 offset:16384
    s_mul_i32 s53, s15, 3072
    s_add_u32 m0, s57, 155648
    s_add_u32 s53, s53, s68
    buffer_load_dwordx4 v14, s[40:43], s53 offen lds
    s_waitcnt lgkmcnt(9)
    s_waitcnt lgkmcnt(6)
    s_waitcnt vmcnt(7)
    v_mfma_f32_32x32x16_bf16 v[88:103], v[36:39], v[196:199], v[88:103]
    s_barrier
    v_mfma_f32_32x32x16_bf16 v[56:71], v[200:203], v[24:27], v[56:71]
    ds_read_b64_tr_b16 v[36:37], v21 offset:30720
    ds_read_b64_tr_b16 v[38:39], v21 offset:31232
    ds_read_b128 v[212:215], v19 offset:16384
    ds_read_b64_tr_b16 v[24:25], v21 offset:32768
    ds_read_b64_tr_b16 v[26:27], v21 offset:33280
    s_mul_i32 s53, s4, 3584
    s_add_u32 m0, s57, 65536
    s_add_u32 s53, s53, s69
    buffer_load_dwordx4 v15, s[32:35], s53 offen lds
    v_lshlrev_b32 v104, 16, v40
    v_and_b32 v105, 0xffff0000, v40
    s_waitcnt lgkmcnt(8)
    v_mfma_f32_32x32x16_bf16 v[56:71], v[204:207], v[28:31], v[56:71]
    ds_read_b64_tr_b16 v[28:29], v21 offset:34816
    ds_read_b64_tr_b16 v[30:31], v21 offset:35328
    v_lshlrev_b32 v112, 16, v44
    v_and_b32 v113, 0xffff0000, v44
    v_lshlrev_b32 v106, 16, v41
    s_waitcnt lgkmcnt(7)
    v_mfma_f32_32x32x16_bf16 v[56:71], v[208:211], v[32:35], v[56:71]
    ds_read_b64_tr_b16 v[32:33], v21 offset:36864
    ds_read_b64_tr_b16 v[34:35], v21 offset:37376
    s_mul_i32 s53, s5, 3584
    s_add_u32 m0, s57, 73728
    s_add_u32 s53, s53, s69
    buffer_load_dwordx4 v15, s[32:35], s53 offen lds
    v_and_b32 v107, 0xffff0000, v41
    v_lshlrev_b32 v114, 16, v45
    v_and_b32 v115, 0xffff0000, v45
    s_waitcnt lgkmcnt(6)
    v_mfma_f32_32x32x16_bf16 v[56:71], v[212:215], v[36:39], v[56:71]
    ds_read_b64_tr_b16 v[36:37], v21 offset:38912
    ds_read_b64_tr_b16 v[38:39], v21 offset:39424
    v_lshlrev_b32 v108, 16, v42
    v_and_b32 v109, 0xffff0000, v42
    v_lshlrev_b32 v116, 16, v46
    s_waitcnt lgkmcnt(6)
    v_mfma_f32_32x32x16_bf16 v[72:87], v[200:203], v[24:27], v[72:87]
    ds_read_b64_tr_b16 v[24:25], v21 offset:40960
    ds_read_b64_tr_b16 v[26:27], v21 offset:41472
    s_mul_i32 s53, s4, 3584
    s_add_u32 m0, s57, 81920
    s_add_u32 s53, s53, s70
    buffer_load_dwordx4 v15, s[36:39], s53 offen lds
    v_and_b32 v117, 0xffff0000, v46
    v_lshlrev_b32 v110, 16, v43
    v_and_b32 v111, 0xffff0000, v43
    s_waitcnt lgkmcnt(6)
    v_mfma_f32_32x32x16_bf16 v[72:87], v[204:207], v[28:31], v[72:87]
    ds_read_b64_tr_b16 v[28:29], v21 offset:43008
    ds_read_b64_tr_b16 v[30:31], v21 offset:43520
    v_lshlrev_b32 v118, 16, v47
    v_and_b32 v119, 0xffff0000, v47
    s_waitcnt lgkmcnt(6)
    v_mfma_f32_32x32x16_bf16 v[72:87], v[208:211], v[32:35], v[72:87]
    ds_read_b64_tr_b16 v[32:33], v21 offset:45056
    ds_read_b64_tr_b16 v[34:35], v21 offset:45568
    s_mul_i32 s53, s5, 3584
    s_add_u32 m0, s57, 0
    s_add_u32 s53, s53, s70
    buffer_load_dwordx4 v15, s[36:39], s53 offen lds
    v_mul_f32 v104, v104, v112
    v_mul_f32 v105, v105, v113
    v_mul_f32 v106, v106, v114
    s_waitcnt lgkmcnt(6)
    v_mfma_f32_32x32x16_bf16 v[72:87], v[212:215], v[36:39], v[72:87]
    ds_read_b64_tr_b16 v[36:37], v21 offset:47104
    ds_read_b64_tr_b16 v[38:39], v21 offset:47616
    v_mul_f32 v107, v107, v115
    v_mul_f32 v108, v108, v116
    v_mul_f32 v109, v109, v117
    s_waitcnt lgkmcnt(6)
    v_mfma_f32_32x32x16_bf16 v[88:103], v[24:27], v[200:203], v[88:103]
    ds_read_b64_tr_b16 v[24:25], v21 offset:49152
    ds_read_b64_tr_b16 v[26:27], v21 offset:49664
    ds_read_b128 v[216:219], v16 offset:32768
    s_mul_i32 s53, s6, 3584
    s_add_u32 m0, s57, 8192
    s_add_u32 s53, s53, s69
    buffer_load_dwordx4 v15, s[32:35], s53 offen lds
    v_mul_f32 v110, v110, v118
    v_mul_f32 v111, v111, v119
    v_cvt_pk_bf16_f32 v112, v104, v105
    s_waitcnt lgkmcnt(7)
    v_mfma_f32_32x32x16_bf16 v[88:103], v[28:31], v[204:207], v[88:103]
    ds_read_b64_tr_b16 v[28:29], v21 offset:51200
    ds_read_b64_tr_b16 v[30:31], v21 offset:51712
    ds_read_b128 v[220:223], v17 offset:32768
    v_cvt_pk_bf16_f32 v113, v106, v107
    v_cvt_pk_bf16_f32 v114, v108, v109
    v_cvt_pk_bf16_f32 v115, v110, v111
    s_waitcnt lgkmcnt(8)
    v_mfma_f32_32x32x16_bf16 v[88:103], v[32:35], v[208:211], v[88:103]
    ds_read_b64_tr_b16 v[32:33], v21 offset:53248
    ds_read_b64_tr_b16 v[34:35], v21 offset:53760
    ds_read_b128 v[224:227], v18 offset:32768
    v_lshlrev_b32 v104, 16, v112
    v_and_b32 v105, 0xffff0000, v112
    s_waitcnt lgkmcnt(9)
    s_waitcnt lgkmcnt(6)
    s_waitcnt vmcnt(7)
    v_mfma_f32_32x32x16_bf16 v[88:103], v[36:39], v[212:215], v[88:103]
    s_barrier
    v_mfma_f32_32x32x16_bf16 v[56:71], v[216:219], v[24:27], v[56:71]
    ds_read_b64_tr_b16 v[36:37], v21 offset:55296
    ds_read_b64_tr_b16 v[38:39], v21 offset:55808
    ds_read_b128 v[228:231], v19 offset:32768
    ds_read_b64_tr_b16 v[24:25], v21 offset:57344
    ds_read_b64_tr_b16 v[26:27], v21 offset:57856
    s_mul_i32 s53, s7, 3584
    s_add_u32 m0, s57, 90112
    s_add_u32 s53, s53, s69
    buffer_load_dwordx4 v15, s[32:35], s53 offen lds
    v_lshlrev_b32 v106, 16, v113
    v_and_b32 v107, 0xffff0000, v113
    v_lshlrev_b32 v108, 16, v114
    s_waitcnt lgkmcnt(8)
    v_mfma_f32_32x32x16_bf16 v[56:71], v[220:223], v[28:31], v[56:71]
    ds_read_b64_tr_b16 v[28:29], v21 offset:59392
    ds_read_b64_tr_b16 v[30:31], v21 offset:59904
    v_and_b32 v109, 0xffff0000, v114
    v_lshlrev_b32 v110, 16, v115
    v_and_b32 v111, 0xffff0000, v115
    s_waitcnt lgkmcnt(7)
    v_mfma_f32_32x32x16_bf16 v[56:71], v[224:227], v[32:35], v[56:71]
    ds_read_b64_tr_b16 v[32:33], v21 offset:61440
    ds_read_b64_tr_b16 v[34:35], v21 offset:61952
    s_mul_i32 s53, s12, 3584
    s_add_u32 m0, s57, 98304
    s_add_u32 s53, s53, s69
    buffer_load_dwordx4 v15, s[32:35], s53 offen lds
    v_add_f32 v104, v104, v108
    v_add_f32 v105, v105, v109
    v_add_f32 v106, v106, v110
    s_waitcnt lgkmcnt(6)
    v_mfma_f32_32x32x16_bf16 v[56:71], v[228:231], v[36:39], v[56:71]
    ds_read_b64_tr_b16 v[36:37], v21 offset:63488
    ds_read_b64_tr_b16 v[38:39], v21 offset:64000
    v_add_f32 v107, v107, v111
    v_add_f32 v104, v104, v106
    v_add_f32 v105, v105, v107
    s_waitcnt lgkmcnt(6)
    v_mfma_f32_32x32x16_bf16 v[72:87], v[216:219], v[24:27], v[72:87]
    ds_read_b64_tr_b16 v[24:25], v22 offset:0
    ds_read_b64_tr_b16 v[26:27], v22 offset:512
    s_mul_i32 s53, s13, 3584
    s_add_u32 m0, s57, 106496
    s_add_u32 s53, s53, s69
    buffer_load_dwordx4 v15, s[32:35], s53 offen lds
    v_add_f32 v104, v104, v105
    s_nop 1
    v_add_f32_dpp v104, v104, v104 row_ror:8 row_mask:0xf bank_mask:0xf
    s_nop 1
    v_add_f32_dpp v104, v104, v104 row_ror:4 row_mask:0xf bank_mask:0xf
    s_waitcnt lgkmcnt(6)
    v_mfma_f32_32x32x16_bf16 v[72:87], v[220:223], v[28:31], v[72:87]
    ds_read_b64_tr_b16 v[28:29], v22 offset:2048
    ds_read_b64_tr_b16 v[30:31], v22 offset:2560
    v_add_f32_dpp v104, v104, v104 row_ror:2 row_mask:0xf bank_mask:0xf
    s_nop 1
    v_add_f32_dpp v104, v104, v104 row_ror:1 row_mask:0xf bank_mask:0xf
    s_waitcnt lgkmcnt(6)
    v_mfma_f32_32x32x16_bf16 v[72:87], v[224:227], v[32:35], v[72:87]
    ds_read_b64_tr_b16 v[32:33], v22 offset:4096
    ds_read_b64_tr_b16 v[34:35], v22 offset:4608
    s_mul_i32 s53, s14, 3584
    s_add_u32 m0, s57, 16384
    s_add_u32 s53, s53, s69
    buffer_load_dwordx4 v15, s[32:35], s53 offen lds
    v_mov_b32 v105, v104
    s_nop 1
    v_permlane16_swap_b32 v104, v105
    v_add_f32 v104, v104, v105
    s_waitcnt lgkmcnt(6)
    v_mfma_f32_32x32x16_bf16 v[72:87], v[228:231], v[36:39], v[72:87]
    ds_read_b64_tr_b16 v[36:37], v22 offset:6144
    ds_read_b64_tr_b16 v[38:39], v22 offset:6656
    v_mov_b32 v105, v104
    s_nop 1
    v_permlane32_swap_b32 v104, v105
    v_add_f32 v104, v104, v105
    s_waitcnt lgkmcnt(6)
    v_mfma_f32_32x32x16_bf16 v[88:103], v[24:27], v[216:219], v[88:103]
    ds_read_b64_tr_b16 v[24:25], v22 offset:8192
    ds_read_b64_tr_b16 v[26:27], v22 offset:8704
    ds_read_b128 v[232:235], v16 offset:49152
    s_mul_i32 s53, s15, 3584
    s_add_u32 m0, s57, 24576
    s_add_u32 s53, s53, s69
    buffer_load_dwordx4 v15, s[32:35], s53 offen lds
    v_cvt_pk_bf16_f32 v104, v104, v104
    v_lshlrev_b32 v104, 16, v104
    v_mul_f32 v104, 0xbfb8aa3b, v104
    s_waitcnt lgkmcnt(7)
    v_mfma_f32_32x32x16_bf16 v[88:103], v[28:31], v[220:223], v[88:103]
    ds_read_b64_tr_b16 v[28:29], v22 offset:10240
    ds_read_b64_tr_b16 v[30:31], v22 offset:10752
    ds_read_b128 v[236:239], v17 offset:49152
    v_exp_f32 v104, v104
    s_nop 0
    v_add_f32 v104, 1.0, v104
    v_rcp_f32 v104, v104
    s_waitcnt lgkmcnt(8)
    v_mfma_f32_32x32x16_bf16 v[88:103], v[32:35], v[224:227], v[88:103]
    ds_read_b64_tr_b16 v[32:33], v22 offset:12288
    ds_read_b64_tr_b16 v[34:35], v22 offset:12800
    ds_read_b128 v[240:243], v18 offset:49152
    v_cvt_pk_bf16_f32 v104, v104, v104
    v_lshlrev_b32 v10, 16, v104
    s_waitcnt lgkmcnt(9)
    s_waitcnt lgkmcnt(6)
    s_waitcnt vmcnt(9)
    v_mfma_f32_32x32x16_bf16 v[88:103], v[36:39], v[228:231], v[88:103]
    s_barrier
    v_mfma_f32_32x32x16_bf16 v[56:71], v[232:235], v[24:27], v[56:71]
    ds_read_b64_tr_b16 v[36:37], v22 offset:14336
    ds_read_b64_tr_b16 v[38:39], v22 offset:14848
    ds_read_b128 v[244:247], v19 offset:49152
    ds_read_b64_tr_b16 v[24:25], v22 offset:16384
    ds_read_b64_tr_b16 v[26:27], v22 offset:16896
    s_mul_i32 s53, s6, 3584
    s_add_u32 m0, s57, 114688
    s_add_u32 s53, s53, s70
    buffer_load_dwordx4 v15, s[36:39], s53 offen lds
    s_waitcnt lgkmcnt(8)
    v_mfma_f32_32x32x16_bf16 v[56:71], v[236:239], v[28:31], v[56:71]
    ds_read_b64_tr_b16 v[28:29], v22 offset:18432
    ds_read_b64_tr_b16 v[30:31], v22 offset:18944
    s_waitcnt lgkmcnt(7)
    v_mfma_f32_32x32x16_bf16 v[56:71], v[240:243], v[32:35], v[56:71]
    ds_read_b64_tr_b16 v[32:33], v22 offset:20480
    ds_read_b64_tr_b16 v[34:35], v22 offset:20992
    s_mul_i32 s53, s7, 3584
    s_add_u32 m0, s57, 122880
    s_add_u32 s53, s53, s70
    buffer_load_dwordx4 v15, s[36:39], s53 offen lds
    s_waitcnt lgkmcnt(6)
    v_mfma_f32_32x32x16_bf16 v[56:71], v[244:247], v[36:39], v[56:71]
    ds_read_b64_tr_b16 v[36:37], v22 offset:22528
    ds_read_b64_tr_b16 v[38:39], v22 offset:23040
    s_waitcnt lgkmcnt(6)
    v_mfma_f32_32x32x16_bf16 v[72:87], v[232:235], v[24:27], v[72:87]
    ds_read_b64_tr_b16 v[24:25], v22 offset:24576
    ds_read_b64_tr_b16 v[26:27], v22 offset:25088
    s_mul_i32 s53, s12, 3584
    s_add_u32 m0, s57, 131072
    s_add_u32 s53, s53, s70
    buffer_load_dwordx4 v15, s[36:39], s53 offen lds
    v_mov_b32 v6, 0
    buffer_load_dwordx2 v[250:251], v6, s[48:51], 0 offen sc1
    s_waitcnt lgkmcnt(6)
    v_mfma_f32_32x32x16_bf16 v[72:87], v[236:239], v[28:31], v[72:87]
    ds_read_b64_tr_b16 v[28:29], v22 offset:26624
    ds_read_b64_tr_b16 v[30:31], v22 offset:27136
    s_waitcnt lgkmcnt(6)
    v_mfma_f32_32x32x16_bf16 v[72:87], v[240:243], v[32:35], v[72:87]
    ds_read_b64_tr_b16 v[32:33], v22 offset:28672
    ds_read_b64_tr_b16 v[34:35], v22 offset:29184
    s_mul_i32 s53, s13, 3584
    s_add_u32 m0, s57, 32768
    s_add_u32 s53, s53, s70
    buffer_load_dwordx4 v15, s[36:39], s53 offen lds
    s_waitcnt lgkmcnt(6)
    v_mfma_f32_32x32x16_bf16 v[72:87], v[244:247], v[36:39], v[72:87]
    ds_read_b64_tr_b16 v[36:37], v22 offset:30720
    ds_read_b64_tr_b16 v[38:39], v22 offset:31232
    s_waitcnt lgkmcnt(6)
    v_mfma_f32_32x32x16_bf16 v[88:103], v[24:27], v[232:235], v[88:103]
    ds_read_b64_tr_b16 v[24:25], v21 offset:0
    ds_read_b64_tr_b16 v[26:27], v21 offset:512
    s_mul_i32 s53, s14, 3584
    s_add_u32 m0, s57, 40960
    s_add_u32 s53, s53, s70
    buffer_load_dwordx4 v15, s[36:39], s53 offen lds
    s_waitcnt lgkmcnt(6)
    v_mfma_f32_32x32x16_bf16 v[88:103], v[28:31], v[236:239], v[88:103]
    ds_read_b64_tr_b16 v[28:29], v21 offset:2048
    ds_read_b64_tr_b16 v[30:31], v21 offset:2560
    s_waitcnt lgkmcnt(6)
    v_mfma_f32_32x32x16_bf16 v[88:103], v[32:35], v[240:243], v[88:103]
    ds_read_b64_tr_b16 v[32:33], v21 offset:4096
    ds_read_b64_tr_b16 v[34:35], v21 offset:4608
    s_waitcnt lgkmcnt(6)
    s_waitcnt lgkmcnt(4)
    s_waitcnt vmcnt(9)
    v_mfma_f32_32x32x16_bf16 v[88:103], v[36:39], v[244:247], v[88:103]
    s_barrier
    v_mfma_f32_32x32x16_bf16 v[104:119], v[24:27], v[120:123], 0
    ds_read_b64_tr_b16 v[36:37], v21 offset:6144
    ds_read_b64_tr_b16 v[38:39], v21 offset:6656
    ds_read_b64_tr_b16 v[24:25], v21 offset:8192
    ds_read_b64_tr_b16 v[26:27], v21 offset:8704
    s_mul_i32 s53, s15, 3584
    s_add_u32 m0, s57, 139264
    s_add_u32 s53, s53, s70
    buffer_load_dwordx4 v15, s[36:39], s53 offen lds
    s_waitcnt lgkmcnt(6)
    v_mfma_f32_32x32x16_bf16 v[104:119], v[28:31], v[124:127], v[104:119]
    ds_read_b64_tr_b16 v[28:29], v21 offset:10240
    ds_read_b64_tr_b16 v[30:31], v21 offset:10752
    v_cvt_pk_bf16_f32 v40, v56, v57
    v_cvt_pk_bf16_f32 v41, v58, v59
    v_cvt_pk_bf16_f32 v42, v60, v61
    v_cvt_pk_bf16_f32 v43, v62, v63
    v_cvt_pk_bf16_f32 v44, v64, v65
    v_cvt_pk_bf16_f32 v45, v66, v67
    s_waitcnt lgkmcnt(6)
    v_mfma_f32_32x32x16_bf16 v[104:119], v[32:35], v[128:131], v[104:119]
    ds_read_b64_tr_b16 v[32:33], v21 offset:12288
    ds_read_b64_tr_b16 v[34:35], v21 offset:12800
    v_cvt_pk_bf16_f32 v46, v68, v69
    v_cvt_pk_bf16_f32 v47, v70, v71
    v_permlane32_swap_b32 v40, v42
    v_permlane32_swap_b32 v41, v43
    v_permlane32_swap_b32 v44, v46
    s_waitcnt lgkmcnt(6)
    v_mfma_f32_32x32x16_bf16 v[104:119], v[36:39], v[132:135], v[104:119]
    ds_read_b64_tr_b16 v[36:37], v21 offset:14336
    ds_read_b64_tr_b16 v[38:39], v21 offset:14848
    v_permlane32_swap_b32 v45, v47
    s_add_u32 s54, s73, 0
    buffer_store_dwordx4 v[40:43], v23, s[44:47], s54 offen sc1
    buffer_store_dwordx4 v[44:47], v23, s[44:47], s54 offen offset:512 sc1
    v_cvt_pk_bf16_f32 v48, v72, v73
    v_cvt_pk_bf16_f32 v49, v74, v75
    v_cvt_pk_bf16_f32 v50, v76, v77
    v_cvt_pk_bf16_f32 v51, v78, v79
    s_waitcnt lgkmcnt(6)
    v_mfma_f32_32x32x16_bf16 v[104:119], v[24:27], v[136:139], v[104:119]
    ds_read_b64_tr_b16 v[24:25], v20 offset:8192
    ds_read_b64_tr_b16 v[26:27], v20 offset:8704
    v_cvt_pk_bf16_f32 v52, v80, v81
    v_cvt_pk_bf16_f32 v53, v82, v83
    v_cvt_pk_bf16_f32 v54, v84, v85
    v_cvt_pk_bf16_f32 v55, v86, v87
    v_permlane32_swap_b32 v48, v50
    s_waitcnt lgkmcnt(6)
    v_mfma_f32_32x32x16_bf16 v[104:119], v[28:31], v[140:143], v[104:119]
    ds_read_b64_tr_b16 v[28:29], v20 offset:10240
    ds_read_b64_tr_b16 v[30:31], v20 offset:10752
    v_permlane32_swap_b32 v49, v51
    v_permlane32_swap_b32 v52, v54
    v_permlane32_swap_b32 v53, v55
    s_add_u32 s54, s73, 262144
    buffer_store_dwordx4 v[48:51], v23, s[44:47], s54 offen sc1
    buffer_store_dwordx4 v[52:55], v23, s[44:47], s54 offen offset:512 sc1
    v_mov_b32 v3, 0
    s_mov_b64 exec, 1
    buffer_store_dword v10, v3, s[44:47], s78 offen sc1
    s_mov_b64 exec, -1
    s_waitcnt lgkmcnt(6)
    v_mfma_f32_32x32x16_bf16 v[104:119], v[32:35], v[144:147], v[104:119]
    ds_read_b64_tr_b16 v[32:33], v20 offset:12288
    ds_read_b64_tr_b16 v[34:35], v20 offset:12800
    v_mul_f32 v88, s72, v88
    v_mul_f32 v89, s72, v89
    v_mul_f32 v90, s72, v90
    v_mul_f32 v91, s72, v91
    v_mul_f32 v92, s72, v92
    s_waitcnt lgkmcnt(6)
    v_mfma_f32_32x32x16_bf16 v[104:119], v[36:39], v[148:151], v[104:119]
    ds_read_b64_tr_b16 v[36:37], v20 offset:14336
    ds_read_b64_tr_b16 v[38:39], v20 offset:14848
    v_mul_f32 v93, s72, v93
    v_mul_f32 v94, s72, v94
    v_mul_f32 v95, s72, v95
    v_mul_f32 v96, s72, v96
    s_waitcnt lgkmcnt(6)
    v_mfma_f32_32x32x16_bf16 v[104:119], v[24:27], v[152:155], v[104:119]
    ds_read_b64_tr_b16 v[24:25], v21 offset:24576
    ds_read_b64_tr_b16 v[26:27], v21 offset:25088
    v_mul_f32 v97, s72, v97
    v_mul_f32 v98, s72, v98
    v_mul_f32 v99, s72, v99
    v_mul_f32 v100, s72, v100
    s_waitcnt lgkmcnt(6)
    v_mfma_f32_32x32x16_bf16 v[104:119], v[28:31], v[156:159], v[104:119]
    ds_read_b64_tr_b16 v[28:29], v21 offset:26624
    ds_read_b64_tr_b16 v[30:31], v21 offset:27136
    v_mul_f32 v101, s72, v101
    v_mul_f32 v102, s72, v102
    v_mul_f32 v103, s72, v103
    v_cvt_pk_bf16_f32 v48, v88, v89
    s_waitcnt lgkmcnt(6)
    v_mfma_f32_32x32x16_bf16 v[104:119], v[32:35], v[160:163], v[104:119]
    ds_read_b64_tr_b16 v[32:33], v21 offset:28672
    ds_read_b64_tr_b16 v[34:35], v21 offset:29184
    v_cvt_pk_bf16_f32 v49, v90, v91
    v_cvt_pk_bf16_f32 v50, v92, v93
    v_cvt_pk_bf16_f32 v51, v94, v95
    v_cvt_pk_bf16_f32 v52, v96, v97
    v_add_u32 v13, s89, v2
    s_waitcnt lgkmcnt(6)
    v_mfma_f32_32x32x16_bf16 v[104:119], v[36:39], v[164:167], v[104:119]
    ds_read_b64_tr_b16 v[36:37], v21 offset:30720
    ds_read_b64_tr_b16 v[38:39], v21 offset:31232
    v_cvt_pk_bf16_f32 v53, v98, v99
    v_cvt_pk_bf16_f32 v54, v100, v101
    v_cvt_pk_bf16_f32 v55, v102, v103
    s_add_u32 s54, s71, 65536
    buffer_store_dwordx4 v[48:51], v2, s[44:47], s71 offen sc1
    buffer_store_dwordx4 v[52:55], v2, s[44:47], s54 offen sc1
    v_lshrrev_b32 v7, 5, v1
    s_waitcnt lgkmcnt(6)
    v_mfma_f32_32x32x16_bf16 v[104:119], v[24:27], v[168:171], v[104:119]
    ds_read_b64_tr_b16 v[24:25], v21 offset:32768
    ds_read_b64_tr_b16 v[26:27], v21 offset:33280
    v_lshlrev_b32 v14, 8, v7
    s_waitcnt lgkmcnt(6)
    v_mfma_f32_32x32x16_bf16 v[104:119], v[28:31], v[172:175], v[104:119]
    ds_read_b64_tr_b16 v[28:29], v21 offset:34816
    ds_read_b64_tr_b16 v[30:31], v21 offset:35328
    v_and_b32 v8, 15, v1
    s_waitcnt lgkmcnt(6)
    v_mfma_f32_32x32x16_bf16 v[104:119], v[32:35], v[176:179], v[104:119]
    ds_read_b64_tr_b16 v[32:33], v21 offset:36864
    ds_read_b64_tr_b16 v[34:35], v21 offset:37376
    v_lshl_add_u32 v14, v8, 4, v14
    s_waitcnt lgkmcnt(6)
    s_waitcnt lgkmcnt(4)
    s_waitcnt vmcnt(14)
    v_mfma_f32_32x32x16_bf16 v[104:119], v[36:39], v[180:183], v[104:119]
    s_barrier
    v_mfma_f32_32x32x16_bf16 v[104:119], v[24:27], v[184:187], v[104:119]
    ds_read_b64_tr_b16 v[36:37], v21 offset:38912
    ds_read_b64_tr_b16 v[38:39], v21 offset:39424
    ds_read_b64_tr_b16 v[24:25], v21 offset:40960
    ds_read_b64_tr_b16 v[26:27], v21 offset:41472
    v_add_u32 v14, 65536, v14
    s_waitcnt lgkmcnt(6)
    v_mfma_f32_32x32x16_bf16 v[104:119], v[28:31], v[188:191], v[104:119]
    ds_read_b64_tr_b16 v[28:29], v21 offset:43008
    ds_read_b64_tr_b16 v[30:31], v21 offset:43520
    v_add_u32 v14, s89, v14
    s_waitcnt lgkmcnt(6)
    v_mfma_f32_32x32x16_bf16 v[104:119], v[32:35], v[192:195], v[104:119]
    ds_read_b64_tr_b16 v[32:33], v21 offset:45056
    ds_read_b64_tr_b16 v[34:35], v21 offset:45568
    v_lshlrev_b32 v7, 9, v7
    s_waitcnt lgkmcnt(6)
    v_mfma_f32_32x32x16_bf16 v[104:119], v[36:39], v[196:199], v[104:119]
    ds_read_b64_tr_b16 v[36:37], v21 offset:47104
    ds_read_b64_tr_b16 v[38:39], v21 offset:47616
    s_waitcnt lgkmcnt(6)
    v_mfma_f32_32x32x16_bf16 v[104:119], v[24:27], v[200:203], v[104:119]
    ds_read_b64_tr_b16 v[24:25], v20 offset:16384
    ds_read_b64_tr_b16 v[26:27], v20 offset:16896
    v_bfe_u32 v8, v1, 2, 2
    s_waitcnt lgkmcnt(6)
    v_mfma_f32_32x32x16_bf16 v[104:119], v[28:31], v[204:207], v[104:119]
    ds_read_b64_tr_b16 v[28:29], v20 offset:18432
    ds_read_b64_tr_b16 v[30:31], v20 offset:18944
    v_lshl_add_u32 v7, v8, 7, v7
    s_waitcnt lgkmcnt(6)
    v_mfma_f32_32x32x16_bf16 v[104:119], v[32:35], v[208:211], v[104:119]
    ds_read_b64_tr_b16 v[32:33], v20 offset:20480
    ds_read_b64_tr_b16 v[34:35], v20 offset:20992
    v_bfe_u32 v8, v1, 3, 1
    s_waitcnt lgkmcnt(6)
    v_mfma_f32_32x32x16_bf16 v[104:119], v[36:39], v[212:215], v[104:119]
    ds_read_b64_tr_b16 v[36:37], v20 offset:22528
    ds_read_b64_tr_b16 v[38:39], v20 offset:23040
    v_lshl_add_u32 v7, v8, 6, v7
    s_waitcnt lgkmcnt(6)
    v_mfma_f32_32x32x16_bf16 v[104:119], v[24:27], v[216:219], v[104:119]
    ds_read_b64_tr_b16 v[24:25], v20 offset:24576
    ds_read_b64_tr_b16 v[26:27], v20 offset:25088
    v_bfe_u32 v8, v1, 4, 1
    s_waitcnt lgkmcnt(6)
    v_mfma_f32_32x32x16_bf16 v[104:119], v[28:31], v[220:223], v[104:119]
    ds_read_b64_tr_b16 v[28:29], v20 offset:26624
    ds_read_b64_tr_b16 v[30:31], v20 offset:27136
    v_lshl_add_u32 v7, v8, 5, v7
    s_waitcnt lgkmcnt(6)
    v_mfma_f32_32x32x16_bf16 v[104:119], v[32:35], v[224:227], v[104:119]
    ds_read_b64_tr_b16 v[32:33], v20 offset:28672
    ds_read_b64_tr_b16 v[34:35], v20 offset:29184
    v_and_b32 v8, 3, v1
    s_waitcnt lgkmcnt(6)
    s_waitcnt lgkmcnt(4)
    s_waitcnt vmcnt(0)
    s_mov_b32 s56, 0
L_non6:
    v_readfirstlane_b32 s58, v250
    v_readfirstlane_b32 s59, v251
    s_cmp_lg_u32 s58, 0
    s_cbranch_scc1 L_nond7
    s_sleep 8
    buffer_load_dwordx2 v[250:251], v6, s[48:51], 0 offen sc1
    s_waitcnt vmcnt(0)
    s_add_u32 s56, s56, 1
    s_cmp_lt_u32 s56, 40000
    s_cbranch_scc1 L_non6
L_nond7:
    v_mfma_f32_32x32x16_bf16 v[104:119], v[36:39], v[228:231], v[104:119]
    s_barrier
    v_mfma_f32_32x32x16_bf16 v[104:119], v[24:27], v[232:235], v[104:119]
    ds_read_b64_tr_b16 v[36:37], v20 offset:30720
    ds_read_b64_tr_b16 v[38:39], v20 offset:31232
    ds_read_b64_tr_b16 v[24:25], v21 offset:16384
    ds_read_b64_tr_b16 v[26:27], v21 offset:16896
    v_mov_b32 v4, s58
    v_mov_b32 v5, s59
    v_mov_b32 v3, 0
    s_mov_b64 exec, 1
    buffer_store_dwordx2 v[4:5], v3, s[44:47], s94 offen sc1
    s_mov_b64 exec, -1
    v_lshl_add_u32 v7, v8, 3, v7
    s_waitcnt lgkmcnt(6)
    v_mfma_f32_32x32x16_bf16 v[104:119], v[28:31], v[236:239], v[104:119]
    ds_read_b64_tr_b16 v[28:29], v21 offset:18432
    ds_read_b64_tr_b16 v[30:31], v21 offset:18944
    s_waitcnt lgkmcnt(6)
    v_mfma_f32_32x32x16_bf16 v[104:119], v[32:35], v[240:243], v[104:119]
    ds_read_b64_tr_b16 v[32:33], v21 offset:20480
    ds_read_b64_tr_b16 v[34:35], v21 offset:20992
    s_lshl_b32 s55, s3, 5
    s_waitcnt lgkmcnt(6)
    v_mfma_f32_32x32x16_bf16 v[104:119], v[36:39], v[244:247], v[104:119]
    ds_read_b64_tr_b16 v[36:37], v21 offset:22528
    ds_read_b64_tr_b16 v[38:39], v21 offset:23040
    v_xor_b32 v7, s55, v7
    s_waitcnt lgkmcnt(6)
    v_mfma_f32_32x32x16_bf16 v[56:71], v[24:27], v[120:123], 0
    ds_read_b64_tr_b16 v[24:25], v20 offset:0
    ds_read_b64_tr_b16 v[26:27], v20 offset:512
    v_add_u32 v18, s84, v7
    s_waitcnt lgkmcnt(6)
    v_mfma_f32_32x32x16_bf16 v[56:71], v[28:31], v[124:127], v[56:71]
    ds_read_b64_tr_b16 v[28:29], v20 offset:2048
    ds_read_b64_tr_b16 v[30:31], v20 offset:2560
    v_xor_b32 v19, 64, v18
    s_waitcnt lgkmcnt(6)
    v_mfma_f32_32x32x16_bf16 v[56:71], v[32:35], v[128:131], v[56:71]
    ds_read_b64_tr_b16 v[32:33], v20 offset:4096
    ds_read_b64_tr_b16 v[34:35], v20 offset:4608
    v_mul_f32 v48, v104, v104
    v_mul_f32 v49, v105, v105
    v_mul_f32 v50, v106, v106
    v_mul_f32 v51, v107, v107
    v_and_b32 v7, 7, v1
    s_waitcnt lgkmcnt(6)
    v_mfma_f32_32x32x16_bf16 v[56:71], v[36:39], v[132:135], v[56:71]
    ds_read_b64_tr_b16 v[36:37], v20 offset:6144
    ds_read_b64_tr_b16 v[38:39], v20 offset:6656
    v_mul_f32 v52, v108, v108
    v_mul_f32 v53, v109, v109
    v_mul_f32 v54, v110, v110
    v_mul_f32 v55, v111, v111
    v_lshrrev_b32 v8, 2, v1
    s_waitcnt lgkmcnt(6)
    v_mfma_f32_32x32x16_bf16 v[56:71], v[24:27], v[136:139], v[56:71]
    ds_read_b64_tr_b16 v[24:25], v21 offset:49152
    ds_read_b64_tr_b16 v[26:27], v21 offset:49664
    v_fma_f32 v48, v48, s74, v248
    v_fma_f32 v49, v49, s74, v248
    v_fma_f32 v50, v50, s74, v248
    v_fma_f32 v51, v51, s74, v248
    v_and_b32 v8, 4, v8
    s_waitcnt lgkmcnt(6)
    v_mfma_f32_32x32x16_bf16 v[56:71], v[28:31], v[140:143], v[56:71]
    ds_read_b64_tr_b16 v[28:29], v21 offset:51200
    ds_read_b64_tr_b16 v[30:31], v21 offset:51712
    v_fma_f32 v52, v52, s74, v248
    v_fma_f32 v53, v53, s74, v248
    v_fma_f32 v54, v54, s74, v248
    v_fma_f32 v55, v55, s74, v248
    v_xor_b32 v7, v7, v8
    s_waitcnt lgkmcnt(6)
    v_mfma_f32_32x32x16_bf16 v[56:71], v[32:35], v[144:147], v[56:71]
    ds_read_b64_tr_b16 v[32:33], v21 offset:53248
    ds_read_b64_tr_b16 v[34:35], v21 offset:53760
    v_mul_f32 v48, v48, v104
    v_mul_f32 v49, v49, v105
    v_mul_f32 v50, v50, v106
    v_mul_f32 v51, v51, v107
    s_waitcnt lgkmcnt(6)
    v_mfma_f32_32x32x16_bf16 v[56:71], v[36:39], v[148:151], v[56:71]
    ds_read_b64_tr_b16 v[36:37], v21 offset:55296
    ds_read_b64_tr_b16 v[38:39], v21 offset:55808
    v_mul_f32 v52, v52, v108
    v_mul_f32 v53, v53, v109
    v_mul_f32 v54, v54, v110
    v_mul_f32 v55, v55, v111
    v_lshlrev_b32 v7, 4, v7
    s_waitcnt lgkmcnt(6)
    v_mfma_f32_32x32x16_bf16 v[56:71], v[24:27], v[152:155], v[56:71]
    ds_read_b64_tr_b16 v[24:25], v21 offset:57344
    ds_read_b64_tr_b16 v[26:27], v21 offset:57856
    v_exp_f32 v48, v48
    v_exp_f32 v49, v49
    v_exp_f32 v50, v50
    v_exp_f32 v51, v51
    v_lshrrev_b32 v8, 3, v1
    s_waitcnt lgkmcnt(6)
    v_mfma_f32_32x32x16_bf16 v[56:71], v[28:31], v[156:159], v[56:71]
    ds_read_b64_tr_b16 v[28:29], v21 offset:59392
    ds_read_b64_tr_b16 v[30:31], v21 offset:59904
    v_exp_f32 v52, v52
    v_exp_f32 v53, v53
    v_exp_f32 v54, v54
    v_lshl_add_u32 v17, v8, 10, v7
    s_waitcnt lgkmcnt(6)
    v_mfma_f32_32x32x16_bf16 v[56:71], v[32:35], v[160:163], v[56:71]
    ds_read_b64_tr_b16 v[32:33], v21 offset:61440
    ds_read_b64_tr_b16 v[34:35], v21 offset:61952
    v_exp_f32 v55, v55
    v_add_f32 v48, 1.0, v48
    v_add_f32 v49, 1.0, v49
    v_add_f32 v50, 1.0, v50
    s_lshl_b32 s55, s83, 7
    s_waitcnt lgkmcnt(6)
    v_mfma_f32_32x32x16_bf16 v[56:71], v[36:39], v[164:167], v[56:71]
    ds_read_b64_tr_b16 v[36:37], v21 offset:63488
    ds_read_b64_tr_b16 v[38:39], v21 offset:64000
    v_add_f32 v51, 1.0, v51
    v_add_f32 v52, 1.0, v52
    v_add_f32 v53, 1.0, v53
    v_add_f32 v54, 1.0, v54
    v_add_u32 v17, s55, v17
    s_waitcnt lgkmcnt(6)
    v_mfma_f32_32x32x16_bf16 v[56:71], v[24:27], v[168:171], v[56:71]
    ds_read_b64_tr_b16 v[24:25], v22 offset:0
    ds_read_b64_tr_b16 v[26:27], v22 offset:512
    v_add_f32 v55, 1.0, v55
    v_rcp_f32 v48, v48
    v_rcp_f32 v49, v49
    v_rcp_f32 v50, v50
    s_mov_b32 s28, s16
    s_and_b32 s29, s17, 0xffff
    s_mov_b32 s30, 1835008
    s_mov_b32 s31, 0x20000
    s_waitcnt lgkmcnt(6)
    v_mfma_f32_32x32x16_bf16 v[56:71], v[28:31], v[172:175], v[56:71]
    ds_read_b64_tr_b16 v[28:29], v22 offset:2048
    ds_read_b64_tr_b16 v[30:31], v22 offset:2560
    v_rcp_f32 v51, v51
    v_rcp_f32 v52, v52
    v_rcp_f32 v53, v53
    v_rcp_f32 v54, v54
    s_mov_b32 s40, s8
    s_and_b32 s41, s9, 0xffff
    s_mov_b32 s42, 524288
    s_mov_b32 s43, 0x20000
    s_waitcnt lgkmcnt(6)
    v_mfma_f32_32x32x16_bf16 v[56:71], v[32:35], v[176:179], v[56:71]
    ds_read_b64_tr_b16 v[32:33], v22 offset:4096
    ds_read_b64_tr_b16 v[34:35], v22 offset:4608
    v_rcp_f32 v55, v55
    v_mul_f32 v104, v104, v48
    v_mul_f32 v105, v105, v49
    v_mul_f32 v106, v106, v50
    s_waitcnt lgkmcnt(6)
    v_mfma_f32_32x32x16_bf16 v[56:71], v[36:39], v[180:183], v[56:71]
    ds_read_b64_tr_b16 v[36:37], v22 offset:6144
    ds_read_b64_tr_b16 v[38:39], v22 offset:6656
    v_mul_f32 v107, v107, v51
    v_mul_f32 v108, v108, v52
    v_mul_f32 v109, v109, v53
    v_mul_f32 v110, v110, v54
    s_waitcnt lgkmcnt(6)
    v_mfma_f32_32x32x16_bf16 v[56:71], v[24:27], v[184:187], v[56:71]
    ds_read_b64_tr_b16 v[24:25], v20 offset:32768
    ds_read_b64_tr_b16 v[26:27], v20 offset:33280
    v_mul_f32 v111, v111, v55
    v_mul_f32 v48, v112, v112
    v_mul_f32 v49, v113, v113
    s_cmp_eq_u32 s52, 0
    s_cselect_b32 s54, 0, 17825792
    buffer_load_dwordx2 v[250:251], v252, s[44:47], s54 offen sc1
    s_waitcnt lgkmcnt(6)
    v_mfma_f32_32x32x16_bf16 v[56:71], v[28:31], v[188:191], v[56:71]
    ds_read_b64_tr_b16 v[28:29], v20 offset:34816
    ds_read_b64_tr_b16 v[30:31], v20 offset:35328
    v_mul_f32 v50, v114, v114
    v_mul_f32 v51, v115, v115
    v_mul_f32 v52, v116, v116
    v_mul_f32 v53, v117, v117
    v_and_b32 v7, 27, v1
    v_cmp_eq_u32 vcc, 16, v7
    v_mov_b32 v8, 0x3f803f80
    s_nop 0
    v_cndmask_b32 v7, 0, v8, vcc
    v_mov_b32 v124, v7
    v_mov_b32 v125, v7
    s_waitcnt lgkmcnt(6)
    v_mfma_f32_32x32x16_bf16 v[56:71], v[32:35], v[192:195], v[56:71]
    ds_read_b64_tr_b16 v[32:33], v20 offset:36864
    ds_read_b64_tr_b16 v[34:35], v20 offset:37376
    v_mul_f32 v54, v118, v118
    v_mul_f32 v55, v119, v119
    v_fma_f32 v48, v48, s74, v248
    v_fma_f32 v49, v49, s74, v248
    v_mov_b32 v126, v7
    v_mov_b32 v127, v7
    s_waitcnt lgkmcnt(6)
    v_mfma_f32_32x32x16_bf16 v[56:71], v[36:39], v[196:199], v[56:71]
    ds_read_b64_tr_b16 v[36:37], v20 offset:38912
    ds_read_b64_tr_b16 v[38:39], v20 offset:39424
    v_fma_f32 v50, v50, s74, v248
    v_fma_f32 v51, v51, s74, v248
    v_fma_f32 v52, v52, s74, v248
    v_fma_f32 v53, v53, s74, v248
    v_mov_b32 v128, v7
    v_mov_b32 v129, v7
    s_waitcnt lgkmcnt(6)
    v_mfma_f32_32x32x16_bf16 v[56:71], v[24:27], v[200:203], v[56:71]
    ds_read_b64_tr_b16 v[24:25], v20 offset:40960
    ds_read_b64_tr_b16 v[26:27], v20 offset:41472
    v_fma_f32 v54, v54, s74, v248
    v_fma_f32 v55, v55, s74, v248
    v_mul_f32 v48, v48, v112
    v_mul_f32 v49, v49, v113
    v_mov_b32 v130, v7
    v_mov_b32 v131, v7
    s_waitcnt lgkmcnt(6)
    v_mfma_f32_32x32x16_bf16 v[56:71], v[28:31], v[204:207], v[56:71]
    ds_read_b64_tr_b16 v[28:29], v20 offset:43008
    ds_read_b64_tr_b16 v[30:31], v20 offset:43520
    v_mul_f32 v50, v50, v114
    v_mul_f32 v51, v51, v115
    v_mul_f32 v52, v52, v116
    v_mul_f32 v53, v53, v117
    v_mov_b32 v140, -1
    v_mov_b32 v141, -1
    s_waitcnt lgkmcnt(6)
    v_mfma_f32_32x32x16_bf16 v[56:71], v[32:35], v[208:211], v[56:71]
    ds_read_b64_tr_b16 v[32:33], v20 offset:45056
    ds_read_b64_tr_b16 v[34:35], v20 offset:45568
    v_mul_f32 v54, v54, v118
    v_mul_f32 v55, v55, v119
    v_exp_f32 v48, v48
    v_exp_f32 v49, v49
    v_mov_b32 v142, -1
    v_mov_b32 v143, -1
    s_waitcnt lgkmcnt(6)
    s_waitcnt lgkmcnt(4)
    s_waitcnt vmcnt(0)
    s_cmp_lg_u32 s52, 0
    s_cbranch_scc1 L_s1d8
    s_mov_b32 s56, 0
L_po9:
    v_cmp_eq_u64 vcc, s[58:59], v[250:251]
    s_nop 0
    s_cmp_eq_u64 vcc, -1
    s_cbranch_scc1 L_pod10
    s_sleep 6
    buffer_load_dwordx2 v[250:251], v252, s[44:47], 0 offen sc1
    s_waitcnt vmcnt(0)
    s_add_u32 s56, s56, 1
    s_cmp_lt_u32 s56, 40000
    s_cbranch_scc1 L_po9
L_pod10:
L_s1d8:
    v_mfma_f32_32x32x16_bf16 v[56:71], v[36:39], v[212:215], v[56:71]
    s_barrier
    v_mfma_f32_32x32x16_bf16 v[56:71], v[24:27], v[216:219], v[56:71]
    ds_read_b64_tr_b16 v[36:37], v20 offset:47104
    ds_read_b64_tr_b16 v[38:39], v20 offset:47616
    ds_read_b64_tr_b16 v[24:25], v22 offset:8192
    ds_read_b64_tr_b16 v[26:27], v22 offset:8704
    v_exp_f32 v50, v50
    v_exp_f32 v51, v51
    v_exp_f32 v52, v52
    buffer_load_dwordx4 v[120:123], v2, s[44:47], s101 offen sc1
    s_xor_b32 s54, s101, 1024
    buffer_load_dwordx4 v[132:135], v2, s[44:47], s54 offen sc1
    s_add_u32 m0, s57, 0
    s_add_u32 s54, s88, 0
    buffer_load_dwordx4 v2, s[44:47], s54 offen sc1 lds
    s_add_u32 m0, s57, 65536
    s_add_u32 s54, s88, 2097152
    buffer_load_dwordx4 v2, s[44:47], s54 offen sc1 lds
    v_mov_b32 v164, 0
    v_mov_b32 v165, 0
    s_waitcnt lgkmcnt(6)
    v_mfma_f32_32x32x16_bf16 v[56:71], v[28:31], v[220:223], v[56:71]
    ds_read_b64_tr_b16 v[28:29], v22 offset:10240
    ds_read_b64_tr_b16 v[30:31], v22 offset:10752
    v_exp_f32 v53, v53
    v_exp_f32 v54, v54
    v_exp_f32 v55, v55
    v_add_f32 v48, 1.0, v48
    v_mov_b32 v166, 0
    v_mov_b32 v167, 0
    v_mov_b32 v168, 0
    s_waitcnt lgkmcnt(6)
    v_mfma_f32_32x32x16_bf16 v[56:71], v[32:35], v[224:227], v[56:71]
    ds_read_b64_tr_b16 v[32:33], v22 offset:12288
    ds_read_b64_tr_b16 v[34:35], v22 offset:12800
    v_add_f32 v49, 1.0, v49
    v_add_f32 v50, 1.0, v50
    v_add_f32 v51, 1.0, v51
    v_add_f32 v52, 1.0, v52
    v_mov_b32 v169, 0
    v_mov_b32 v170, 0
    s_waitcnt lgkmcnt(6)
    v_mfma_f32_32x32x16_bf16 v[56:71], v[36:39], v[228:231], v[56:71]
    ds_read_b64_tr_b16 v[36:37], v22 offset:14336
    ds_read_b64_tr_b16 v[38:39], v22 offset:14848
    v_add_f32 v53, 1.0, v53
    v_add_f32 v54, 1.0, v54
    v_add_f32 v55, 1.0, v55
    v_rcp_f32 v48, v48
    s_add_u32 m0, s57, 32768
    s_add_u32 s54, s88, 32768
    buffer_load_dwordx4 v2, s[44:47], s54 offen sc1 lds
    s_add_u32 m0, s57, 98304
    s_add_u32 s54, s88, 2129920
    buffer_load_dwordx4 v2, s[44:47], s54 offen sc1 lds
    v_mov_b32 v171, 0
    v_mov_b32 v172, 0
    s_waitcnt lgkmcnt(6)
    v_mfma_f32_32x32x16_bf16 v[56:71], v[24:27], v[232:235], v[56:71]
    v_rcp_f32 v49, v49
    v_rcp_f32 v50, v50
    v_rcp_f32 v51, v51
    v_rcp_f32 v52, v52
    v_mov_b32 v173, 0
    v_mov_b32 v174, 0
    s_waitcnt lgkmcnt(4)
    v_mfma_f32_32x32x16_bf16 v[56:71], v[28:31], v[236:239], v[56:71]
    v_rcp_f32 v53, v53
    v_rcp_f32 v54, v54
    v_rcp_f32 v55, v55
    v_mul_f32 v112, v112, v48
    v_mov_b32 v175, 0
    v_mov_b32 v176, 0
    s_waitcnt lgkmcnt(2)
    v_mfma_f32_32x32x16_bf16 v[56:71], v[32:35], v[240:243], v[56:71]
    v_mul_f32 v113, v113, v49
    v_mul_f32 v114, v114, v50
    v_mul_f32 v115, v115, v51
    v_mul_f32 v116, v116, v52
    v_mov_b32 v177, 0
    v_mov_b32 v178, 0
    s_waitcnt lgkmcnt(0)
    v_mfma_f32_32x32x16_bf16 v[56:71], v[36:39], v[244:247], v[56:71]
    v_mul_f32 v117, v117, v53
    v_mul_f32 v118, v118, v54
    v_mul_f32 v119, v119, v55
    v_mov_b32 v179, 0
    s_mov_b32 s48, s20
    s_and_b32 s49, s21, 0xffff
    s_mov_b32 s50, 2097152
    s_mov_b32 s51, 0x20000
L_attn:
    s_setprio 3
    s_nop 10
    v_pk_mul_f32 v[56:57], v[56:57], v[104:105]
    v_pk_mul_f32 v[58:59], v[58:59], v[106:107]
    v_pk_mul_f32 v[60:61], v[60:61], v[108:109]
    v_pk_mul_f32 v[62:63], v[62:63], v[110:111]
    v_pk_mul_f32 v[64:65], v[64:65], v[112:113]
    v_pk_mul_f32 v[66:67], v[66:67], v[114:115]
    v_pk_mul_f32 v[68:69], v[68:69], v[116:117]
    v_pk_mul_f32 v[70:71], v[70:71], v[118:119]
    v_cvt_pk_bf16_f32 v156, v56, v57
    v_cvt_pk_bf16_f32 v157, v58, v59
    v_cvt_pk_bf16_f32 v158, v60, v61
    v_cvt_pk_bf16_f32 v159, v62, v63
    v_cvt_pk_bf16_f32 v160, v64, v65
    v_cvt_pk_bf16_f32 v161, v66, v67
    v_cvt_pk_bf16_f32 v162, v68, v69
    v_cvt_pk_bf16_f32 v163, v70, v71
    s_waitcnt vmcnt(0)
    s_barrier
    ds_read_b128 v[72:75], v2
    ds_read_b128 v[180:183], v13
    s_mov_b64 exec, s[92:93]
    ds_read_b128 v[124:127], v14
    ds_read_b128 v[128:131], v14 offset:512
    s_mov_b64 exec, -1
    v_mfma_f32_32x32x16_bf16 v[104:119], v[164:167], v[164:167], 0
    s_waitcnt lgkmcnt(3)
    v_mfma_f32_32x32x16_bf16 v[184:199], v[72:75], v[120:123], 0
    v_mfma_f32_32x32x16_bf16 v[200:215], v[72:75], v[132:135], 0
    s_add_u32 m0, s57, 8192
    s_add_u32 s54, s88, 8192
    buffer_load_dwordx4 v2, s[44:47], s54 offen sc1 lds
    s_add_u32 m0, s57, 73728
    s_add_u32 s54, s88, 2105344
    buffer_load_dwordx4 v2, s[44:47], s54 offen sc1 lds
    s_nop 4
    v_max3_f32 v3, v184, v185, v186
    v_max3_f32 v4, v187, v188, v189
    v_max3_f32 v5, v190, v191, v192
    v_max3_f32 v6, v193, v194, v195
    v_max3_f32 v3, v3, v196, v197
    v_max3_f32 v4, v4, v198, v199
    v_max3_f32 v3, v3, v4, v5
    v_max_f32 v7, v3, v6
    v_max3_f32 v3, v200, v201, v202
    v_max3_f32 v4, v203, v204, v205
    v_max3_f32 v5, v206, v207, v208
    v_max3_f32 v6, v209, v210, v211
    v_max3_f32 v3, v3, v212, v213
    v_max3_f32 v4, v4, v214, v215
    v_max3_f32 v3, v3, v4, v5
    v_max3_f32 v7, v3, v6, v7
    v_mov_b32 v4, v7
    s_nop 1
    v_permlane32_swap_b32 v7, v4
    v_max_f32 v7, v7, v4
    v_sub_f32 v24, 0, v7
    v_sub_f32 v25, 0, v7
    v_sub_f32 v26, 0, v7
    v_sub_f32 v27, 0, v7
    v_sub_f32 v28, 0, v7
    v_sub_f32 v29, 0, v7
    v_sub_f32 v30, 0, v7
    v_sub_f32 v31, 0, v7
    v_sub_f32 v32, 0, v7
    v_sub_f32 v33, 0, v7
    v_sub_f32 v34, 0, v7
    v_sub_f32 v35, 0, v7
    v_sub_f32 v36, 0, v7
    v_sub_f32 v37, 0, v7
    v_sub_f32 v38, 0, v7
    v_sub_f32 v39, 0, v7
    s_waitcnt lgkmcnt(0)
    s_nop 0
    v_mfma_f32_32x32x16_bf16 v[40:55], v[180:183], v[132:135], v[24:39]
    v_mfma_f32_32x32x16_bf16 v[56:71], v[180:183], v[120:123], v[24:39]
    ds_read_b128 v[180:183], v13 offset:1024
    s_add_u32 m0, s57, 40960
    s_add_u32 s54, s88, 40960
    buffer_load_dwordx4 v2, s[44:47], s54 offen sc1 lds
    s_add_u32 m0, s57, 106496
    s_add_u32 s54, s88, 2138112
    buffer_load_dwordx4 v2, s[44:47], s54 offen sc1 lds
    s_setprio 0
    s_nop 2
    v_exp_f32 v40, v40
    s_setprio 2
    v_exp_f32 v41, v41
    v_exp_f32 v42, v42
    v_exp_f32 v43, v43
    v_exp_f32 v44, v44
    v_exp_f32 v45, v45
    v_exp_f32 v46, v46
    v_exp_f32 v47, v47
    v_exp_f32 v48, v48
    v_exp_f32 v49, v49
    v_exp_f32 v50, v50
    v_exp_f32 v51, v51
    v_exp_f32 v52, v52
    v_exp_f32 v53, v53
    v_exp_f32 v54, v54
    s_setprio 3
    v_exp_f32 v55, v55
    s_waitcnt lgkmcnt(0)
    v_smfmac_f32_32x32x32_bf16 v[104:119], v[124:127], v[40:47], v254
    s_add_u32 m0, s57, 16384
    s_add_u32 s54, s88, 16384
    buffer_load_dwordx4 v2, s[44:47], s54 offen sc1 lds
    v_smfmac_f32_32x32x32_bf16 v[104:119], v[128:131], v[48:55], v254
    s_add_u32 m0, s57, 81920
    s_add_u32 s54, s88, 2113536
    buffer_load_dwordx4 v2, s[44:47], s54 offen sc1 lds
    v_mfma_f32_32x32x16_bf16 v[40:55], v[180:183], v[132:135], v[24:39]
    s_setprio 0
    v_exp_f32 v56, v56
    s_setprio 2
    v_exp_f32 v57, v57
    v_exp_f32 v58, v58
    v_exp_f32 v59, v59
    v_exp_f32 v60, v60
    v_exp_f32 v61, v61
    v_exp_f32 v62, v62
    v_exp_f32 v63, v63
    v_exp_f32 v64, v64
    v_exp_f32 v65, v65
    v_exp_f32 v66, v66
    v_exp_f32 v67, v67
    v_exp_f32 v68, v68
    v_exp_f32 v69, v69
    v_exp_f32 v70, v70
    s_setprio 3
    v_exp_f32 v71, v71
    s_waitcnt lgkmcnt(0)
    v_smfmac_f32_32x32x32_bf16 v[164:179], v[124:127], v[56:63], v254
    s_add_u32 m0, s57, 49152
    s_add_u32 s54, s88, 49152
    buffer_load_dwordx4 v2, s[44:47], s54 offen sc1 lds
    v_smfmac_f32_32x32x32_bf16 v[164:179], v[128:131], v[64:71], v254
    s_mov_b64 exec, s[92:93]
    ds_read_b128 v[124:127], v14 offset:1024
    ds_read_b128 v[128:131], v14 offset:1536
    s_mov_b64 exec, -1
    s_add_u32 m0, s57, 114688
    s_add_u32 s54, s88, 2146304
    buffer_load_dwordx4 v2, s[44:47], s54 offen sc1 lds
    v_mfma_f32_32x32x16_bf16 v[56:71], v[180:183], v[120:123], v[24:39]
    ds_read_b128 v[180:183], v13 offset:2048
    s_setprio 0
    v_exp_f32 v40, v40
    s_setprio 2
    v_exp_f32 v41, v41
    v_exp_f32 v42, v42
    v_exp_f32 v43, v43
    v_exp_f32 v44, v44
    v_exp_f32 v45, v45
    v_exp_f32 v46, v46
    v_exp_f32 v47, v47
    v_exp_f32 v48, v48
    v_exp_f32 v49, v49
    v_exp_f32 v50, v50
    v_exp_f32 v51, v51
    v_exp_f32 v52, v52
    v_exp_f32 v53, v53
    v_exp_f32 v54, v54
    s_setprio 3
    v_exp_f32 v55, v55
    s_waitcnt lgkmcnt(0)
    v_smfmac_f32_32x32x32_bf16 v[104:119], v[124:127], v[40:47], v254
    s_add_u32 m0, s57, 24576
    s_add_u32 s54, s88, 24576
    buffer_load_dwordx4 v2, s[44:47], s54 offen sc1 lds
    v_smfmac_f32_32x32x32_bf16 v[104:119], v[128:131], v[48:55], v254
    s_add_u32 m0, s57, 90112
    s_add_u32 s54, s88, 2121728
    buffer_load_dwordx4 v2, s[44:47], s54 offen sc1 lds
    v_mfma_f32_32x32x16_bf16 v[40:55], v[180:183], v[132:135], v[24:39]
    s_setprio 0
    v_exp_f32 v56, v56
    s_setprio 2
    v_exp_f32 v57, v57
    v_exp_f32 v58, v58
    v_exp_f32 v59, v59
    v_exp_f32 v60, v60
    v_exp_f32 v61, v61
    v_exp_f32 v62, v62
    v_exp_f32 v63, v63
    v_exp_f32 v64, v64
    v_exp_f32 v65, v65
    v_exp_f32 v66, v66
    v_exp_f32 v67, v67
    v_exp_f32 v68, v68
    v_exp_f32 v69, v69
    v_exp_f32 v70, v70
    s_setprio 3
    v_exp_f32 v71, v71
    s_waitcnt lgkmcnt(0)
    v_smfmac_f32_32x32x32_bf16 v[164:179], v[124:127], v[56:63], v254
    s_add_u32 m0, s57, 57344
    s_add_u32 s54, s88, 57344
    buffer_load_dwordx4 v2, s[44:47], s54 offen sc1 lds
    v_smfmac_f32_32x32x32_bf16 v[164:179], v[128:131], v[64:71], v254
    s_mov_b64 exec, s[92:93]
    ds_read_b128 v[124:127], v14 offset:2048
    ds_read_b128 v[128:131], v14 offset:2560
    s_mov_b64 exec, -1
    s_add_u32 m0, s57, 122880
    s_add_u32 s54, s88, 2154496
    buffer_load_dwordx4 v2, s[44:47], s54 offen sc1 lds
    v_mfma_f32_32x32x16_bf16 v[56:71], v[180:183], v[120:123], v[24:39]
    ds_read_b128 v[180:183], v13 offset:3072
    s_setprio 0
    v_exp_f32 v40, v40
    s_setprio 2
    v_exp_f32 v41, v41
    v_exp_f32 v42, v42
    v_exp_f32 v43, v43
    v_exp_f32 v44, v44
    v_exp_f32 v45, v45
    v_exp_f32 v46, v46
    v_exp_f32 v47, v47
    v_exp_f32 v48, v48
    v_exp_f32 v49, v49
    v_exp_f32 v50, v50
    v_exp_f32 v51, v51
    v_exp_f32 v52, v52
    v_exp_f32 v53, v53
    v_exp_f32 v54, v54
    s_setprio 3
    v_exp_f32 v55, v55
    s_waitcnt lgkmcnt(0)
    v_smfmac_f32_32x32x32_bf16 v[104:119], v[124:127], v[40:47], v254
    buffer_store_dwordx4 v[148:151], v2, s[44:47], s76 offen offset:0 sc1
    v_smfmac_f32_32x32x32_bf16 v[104:119], v[128:131], v[48:55], v254
    v_mfma_f32_32x32x16_bf16 v[40:55], v[180:183], v[132:135], v[24:39]
    s_setprio 0
    v_exp_f32 v56, v56
    s_setprio 2
    v_exp_f32 v57, v57
    v_exp_f32 v58, v58
    v_exp_f32 v59, v59
    v_exp_f32 v60, v60
    v_exp_f32 v61, v61
    v_exp_f32 v62, v62
    v_exp_f32 v63, v63
    v_exp_f32 v64, v64
    v_exp_f32 v65, v65
    v_exp_f32 v66, v66
    v_exp_f32 v67, v67
    v_exp_f32 v68, v68
    v_exp_f32 v69, v69
    v_exp_f32 v70, v70
    s_setprio 3
    v_exp_f32 v71, v71
    s_waitcnt lgkmcnt(0)
    v_smfmac_f32_32x32x32_bf16 v[164:179], v[124:127], v[56:63], v254
    buffer_store_dwordx4 v[152:155], v2, s[44:47], s76 offen offset:1024 sc1
    v_smfmac_f32_32x32x32_bf16 v[164:179], v[128:131], v[64:71], v254
    s_mov_b64 exec, s[92:93]
    ds_read_b128 v[124:127], v14 offset:3072
    ds_read_b128 v[128:131], v14 offset:3584
    s_mov_b64 exec, -1
    v_mfma_f32_32x32x16_bf16 v[56:71], v[180:183], v[120:123], v[24:39]
    ds_read_b128 v[180:183], v13 offset:4096
    s_setprio 0
    v_exp_f32 v40, v40
    s_setprio 2
    v_exp_f32 v41, v41
    v_exp_f32 v42, v42
    v_exp_f32 v43, v43
    v_exp_f32 v44, v44
    v_exp_f32 v45, v45
    v_exp_f32 v46, v46
    v_exp_f32 v47, v47
    v_exp_f32 v48, v48
    v_exp_f32 v49, v49
    v_exp_f32 v50, v50
    v_exp_f32 v51, v51
    v_exp_f32 v52, v52
    v_exp_f32 v53, v53
    v_exp_f32 v54, v54
    s_setprio 3
    v_exp_f32 v55, v55
    s_waitcnt lgkmcnt(0)
    v_smfmac_f32_32x32x32_bf16 v[104:119], v[124:127], v[40:47], v254
    buffer_store_dwordx4 v[156:159], v2, s[44:47], s77 offen offset:0 sc1
    v_smfmac_f32_32x32x32_bf16 v[104:119], v[128:131], v[48:55], v254
    v_mfma_f32_32x32x16_bf16 v[40:55], v[180:183], v[132:135], v[24:39]
    s_setprio 0
    v_exp_f32 v56, v56
    s_setprio 2
    v_exp_f32 v57, v57
    v_exp_f32 v58, v58
    v_exp_f32 v59, v59
    v_exp_f32 v60, v60
    v_exp_f32 v61, v61
    v_exp_f32 v62, v62
    v_exp_f32 v63, v63
    v_exp_f32 v64, v64
    v_exp_f32 v65, v65
    v_exp_f32 v66, v66
    v_exp_f32 v67, v67
    v_exp_f32 v68, v68
    v_exp_f32 v69, v69
    v_exp_f32 v70, v70
    s_setprio 3
    v_exp_f32 v71, v71
    s_waitcnt lgkmcnt(0)
    v_smfmac_f32_32x32x32_bf16 v[164:179], v[124:127], v[56:63], v254
    buffer_store_dwordx4 v[160:163], v2, s[44:47], s77 offen offset:1024 sc1
    v_smfmac_f32_32x32x32_bf16 v[164:179], v[128:131], v[64:71], v254
    s_mov_b64 exec, s[92:93]
    ds_read_b128 v[124:127], v14 offset:4096
    ds_read_b128 v[128:131], v14 offset:4608
    s_mov_b64 exec, -1
    v_mfma_f32_32x32x16_bf16 v[56:71], v[180:183], v[120:123], v[24:39]
    ds_read_b128 v[180:183], v13 offset:5120
    s_setprio 0
    v_exp_f32 v40, v40
    s_setprio 2
    v_exp_f32 v41, v41
    v_exp_f32 v42, v42
    v_exp_f32 v43, v43
    v_exp_f32 v44, v44
    v_exp_f32 v45, v45
    v_exp_f32 v46, v46
    v_exp_f32 v47, v47
    v_exp_f32 v48, v48
    v_exp_f32 v49, v49
    v_exp_f32 v50, v50
    v_exp_f32 v51, v51
    v_exp_f32 v52, v52
    v_exp_f32 v53, v53
    v_exp_f32 v54, v54
    s_setprio 3
    v_exp_f32 v55, v55
    s_waitcnt lgkmcnt(0)
    v_smfmac_f32_32x32x32_bf16 v[104:119], v[124:127], v[40:47], v254
    buffer_store_dwordx4 v[140:143], v2, s[44:47], s95 offen sc1
    v_smfmac_f32_32x32x32_bf16 v[104:119], v[128:131], v[48:55], v254
    v_mfma_f32_32x32x16_bf16 v[40:55], v[180:183], v[132:135], v[24:39]
    s_setprio 0
    v_exp_f32 v56, v56
    s_setprio 2
    v_exp_f32 v57, v57
    v_exp_f32 v58, v58
    v_exp_f32 v59, v59
    v_exp_f32 v60, v60
    v_exp_f32 v61, v61
    v_exp_f32 v62, v62
    v_exp_f32 v63, v63
    v_exp_f32 v64, v64
    v_exp_f32 v65, v65
    v_exp_f32 v66, v66
    v_exp_f32 v67, v67
    v_exp_f32 v68, v68
    v_exp_f32 v69, v69
    v_exp_f32 v70, v70
    s_setprio 3
    v_exp_f32 v71, v71
    s_waitcnt lgkmcnt(0)
    v_smfmac_f32_32x32x32_bf16 v[164:179], v[124:127], v[56:63], v254
    v_smfmac_f32_32x32x32_bf16 v[164:179], v[128:131], v[64:71], v254
    s_mov_b64 exec, s[92:93]
    ds_read_b128 v[124:127], v14 offset:5120
    ds_read_b128 v[128:131], v14 offset:5632
    s_mov_b64 exec, -1
    v_mfma_f32_32x32x16_bf16 v[56:71], v[180:183], v[120:123], v[24:39]
    ds_read_b128 v[180:183], v13 offset:6144
    s_setprio 0
    v_exp_f32 v40, v40
    s_setprio 2
    v_exp_f32 v41, v41
    v_exp_f32 v42, v42
    v_exp_f32 v43, v43
    v_exp_f32 v44, v44
    v_exp_f32 v45, v45
    v_exp_f32 v46, v46
    v_exp_f32 v47, v47
    v_exp_f32 v48, v48
    v_exp_f32 v49, v49
    v_exp_f32 v50, v50
    v_exp_f32 v51, v51
    v_exp_f32 v52, v52
    v_exp_f32 v53, v53
    v_exp_f32 v54, v54
    s_setprio 3
    v_exp_f32 v55, v55
    s_waitcnt lgkmcnt(0)
    v_smfmac_f32_32x32x32_bf16 v[104:119], v[124:127], v[40:47], v254
    v_smfmac_f32_32x32x32_bf16 v[104:119], v[128:131], v[48:55], v254
    v_mfma_f32_32x32x16_bf16 v[40:55], v[180:183], v[132:135], v[24:39]
    s_waitcnt vmcnt(5)
    s_setprio 0
    v_exp_f32 v56, v56
    s_setprio 2
    v_exp_f32 v57, v57
    v_exp_f32 v58, v58
    v_exp_f32 v59, v59
    v_exp_f32 v60, v60
    v_exp_f32 v61, v61
    v_exp_f32 v62, v62
    v_exp_f32 v63, v63
    v_exp_f32 v64, v64
    v_exp_f32 v65, v65
    v_exp_f32 v66, v66
    v_exp_f32 v67, v67
    v_exp_f32 v68, v68
    v_exp_f32 v69, v69
    v_exp_f32 v70, v70
    s_setprio 3
    v_exp_f32 v71, v71
    s_waitcnt lgkmcnt(0)
    s_cmp_eq_u32 s63, 0
    s_cbranch_scc1 L_ab11
    s_barrier
L_ab11:
    v_smfmac_f32_32x32x32_bf16 v[164:179], v[124:127], v[56:63], v254
    v_smfmac_f32_32x32x32_bf16 v[164:179], v[128:131], v[64:71], v254
    s_mov_b64 exec, s[92:93]
    ds_read_b128 v[124:127], v14 offset:6144
    ds_read_b128 v[128:131], v14 offset:6656
    s_mov_b64 exec, -1
    v_mfma_f32_32x32x16_bf16 v[56:71], v[180:183], v[120:123], v[24:39]
    ds_read_b128 v[180:183], v13 offset:7168
    s_cmp_eq_u32 s63, 1
    s_cbranch_scc1 L_ab12
    s_barrier
L_ab12:
    s_setprio 0
    v_exp_f32 v40, v40
    s_setprio 2
    v_exp_f32 v41, v41
    v_exp_f32 v42, v42
    v_exp_f32 v43, v43
    v_exp_f32 v44, v44
    v_exp_f32 v45, v45
    v_exp_f32 v46, v46
    v_exp_f32 v47, v47
    v_exp_f32 v48, v48
    v_exp_f32 v49, v49
    v_exp_f32 v50, v50
    v_exp_f32 v51, v51
    v_exp_f32 v52, v52
    v_exp_f32 v53, v53
    v_exp_f32 v54, v54
    s_setprio 3
    v_exp_f32 v55, v55
    s_waitcnt lgkmcnt(0)
    v_smfmac_f32_32x32x32_bf16 v[104:119], v[124:127], v[40:47], v254
    v_smfmac_f32_32x32x32_bf16 v[104:119], v[128:131], v[48:55], v254
    v_mfma_f32_32x32x16_bf16 v[40:55], v[180:183], v[132:135], v[24:39]
    s_setprio 0
    v_exp_f32 v56, v56
    s_setprio 2
    v_exp_f32 v57, v57
    v_exp_f32 v58, v58
    v_exp_f32 v59, v59
    v_exp_f32 v60, v60
    v_exp_f32 v61, v61
    v_exp_f32 v62, v62
    v_exp_f32 v63, v63
    v_exp_f32 v64, v64
    v_exp_f32 v65, v65
    v_exp_f32 v66, v66
    v_exp_f32 v67, v67
    v_exp_f32 v68, v68
    v_exp_f32 v69, v69
    v_exp_f32 v70, v70
    s_setprio 3
    v_exp_f32 v71, v71
    s_waitcnt lgkmcnt(0)
    v_smfmac_f32_32x32x32_bf16 v[164:179], v[124:127], v[56:63], v254
    v_smfmac_f32_32x32x32_bf16 v[164:179], v[128:131], v[64:71], v254
    s_mov_b64 exec, s[92:93]
    ds_read_b128 v[124:127], v14 offset:7168
    ds_read_b128 v[128:131], v14 offset:7680
    s_mov_b64 exec, -1
    v_mfma_f32_32x32x16_bf16 v[56:71], v[180:183], v[120:123], v[24:39]
    ds_read_b128 v[180:183], v13 offset:8192
    s_setprio 0
    v_exp_f32 v40, v40
    s_setprio 2
    v_exp_f32 v41, v41
    v_exp_f32 v42, v42
    v_exp_f32 v43, v43
    v_exp_f32 v44, v44
    v_exp_f32 v45, v45
    v_exp_f32 v46, v46
    v_exp_f32 v47, v47
    v_exp_f32 v48, v48
    v_exp_f32 v49, v49
    v_exp_f32 v50, v50
    v_exp_f32 v51, v51
    v_exp_f32 v52, v52
    v_exp_f32 v53, v53
    v_exp_f32 v54, v54
    s_setprio 3
    v_exp_f32 v55, v55
    s_waitcnt lgkmcnt(0)
    v_smfmac_f32_32x32x32_bf16 v[104:119], v[124:127], v[40:47], v254
    v_smfmac_f32_32x32x32_bf16 v[104:119], v[128:131], v[48:55], v254
    v_mfma_f32_32x32x16_bf16 v[40:55], v[180:183], v[132:135], v[24:39]
    s_setprio 0
    v_exp_f32 v56, v56
    s_setprio 2
    v_exp_f32 v57, v57
    v_exp_f32 v58, v58
    v_exp_f32 v59, v59
    v_exp_f32 v60, v60
    v_exp_f32 v61, v61
    v_exp_f32 v62, v62
    v_exp_f32 v63, v63
    v_exp_f32 v64, v64
    v_exp_f32 v65, v65
    v_exp_f32 v66, v66
    v_exp_f32 v67, v67
    v_exp_f32 v68, v68
    v_exp_f32 v69, v69
    v_exp_f32 v70, v70
    s_setprio 3
    v_exp_f32 v71, v71
    s_waitcnt lgkmcnt(0)
    v_smfmac_f32_32x32x32_bf16 v[164:179], v[124:127], v[56:63], v254
    v_smfmac_f32_32x32x32_bf16 v[164:179], v[128:131], v[64:71], v254
    s_mov_b64 exec, s[92:93]
    ds_read_b128 v[124:127], v14 offset:8192
    ds_read_b128 v[128:131], v14 offset:8704
    s_mov_b64 exec, -1
    v_mfma_f32_32x32x16_bf16 v[56:71], v[180:183], v[120:123], v[24:39]
    ds_read_b128 v[180:183], v13 offset:9216
    s_waitcnt vmcnt(0)
    v_mov_b32 v4, s58
    v_mov_b32 v5, s59
    v_mov_b32 v3, 0
    s_mov_b64 exec, 1
    buffer_store_dwordx2 v[4:5], v3, s[44:47], s90 offen sc1
    s_mov_b64 exec, -1
    s_setprio 0
    v_exp_f32 v40, v40
    s_setprio 2
    v_exp_f32 v41, v41
    v_exp_f32 v42, v42
    v_exp_f32 v43, v43
    v_exp_f32 v44, v44
    v_exp_f32 v45, v45
    v_exp_f32 v46, v46
    v_exp_f32 v47, v47
    v_exp_f32 v48, v48
    v_exp_f32 v49, v49
    v_exp_f32 v50, v50
    v_exp_f32 v51, v51
    v_exp_f32 v52, v52
    v_exp_f32 v53, v53
    v_exp_f32 v54, v54
    s_setprio 3
    v_exp_f32 v55, v55
    s_waitcnt lgkmcnt(0)
    v_smfmac_f32_32x32x32_bf16 v[104:119], v[124:127], v[40:47], v254
    v_smfmac_f32_32x32x32_bf16 v[104:119], v[128:131], v[48:55], v254
    v_mfma_f32_32x32x16_bf16 v[40:55], v[180:183], v[132:135], v[24:39]
    s_lshl3_add_u32 s54, s2, s52
    s_mul_i32 s53, s54, 896
    v_min_u32 v7, 6, v1
    v_lshlrev_b32 v7, 7, v7
    buffer_load_dword v8, v7, s[28:31], s53 offen
    s_lshl_b32 s53, s54, 8
    v_and_b32 v7, 128, v7
    buffer_load_dword v9, v7, s[40:43], s53 offen
    s_setprio 0
    v_exp_f32 v56, v56
    s_setprio 2
    v_exp_f32 v57, v57
    v_exp_f32 v58, v58
    v_exp_f32 v59, v59
    v_exp_f32 v60, v60
    v_exp_f32 v61, v61
    v_exp_f32 v62, v62
    v_exp_f32 v63, v63
    v_exp_f32 v64, v64
    v_exp_f32 v65, v65
    v_exp_f32 v66, v66
    v_exp_f32 v67, v67
    v_exp_f32 v68, v68
    v_exp_f32 v69, v69
    v_exp_f32 v70, v70
    s_setprio 3
    v_exp_f32 v71, v71
    s_waitcnt lgkmcnt(0)
    v_smfmac_f32_32x32x32_bf16 v[164:179], v[124:127], v[56:63], v254
    v_smfmac_f32_32x32x32_bf16 v[164:179], v[128:131], v[64:71], v254
    s_mov_b64 exec, s[92:93]
    ds_read_b128 v[124:127], v14 offset:9216
    ds_read_b128 v[128:131], v14 offset:9728
    s_mov_b64 exec, -1
    v_mfma_f32_32x32x16_bf16 v[56:71], v[180:183], v[120:123], v[24:39]
    ds_read_b128 v[180:183], v13 offset:10240
    s_setprio 0
    v_exp_f32 v40, v40
    s_setprio 2
    v_exp_f32 v41, v41
    v_exp_f32 v42, v42
    v_exp_f32 v43, v43
    v_exp_f32 v44, v44
    v_exp_f32 v45, v45
    v_exp_f32 v46, v46
    v_exp_f32 v47, v47
    v_exp_f32 v48, v48
    v_exp_f32 v49, v49
    v_exp_f32 v50, v50
    v_exp_f32 v51, v51
    v_exp_f32 v52, v52
    v_exp_f32 v53, v53
    v_exp_f32 v54, v54
    s_setprio 3
    v_exp_f32 v55, v55
    s_waitcnt lgkmcnt(0)
    v_smfmac_f32_32x32x32_bf16 v[104:119], v[124:127], v[40:47], v254
    v_smfmac_f32_32x32x32_bf16 v[104:119], v[128:131], v[48:55], v254
    v_mfma_f32_32x32x16_bf16 v[40:55], v[180:183], v[132:135], v[24:39]
    s_setprio 0
    v_exp_f32 v56, v56
    s_setprio 2
    v_exp_f32 v57, v57
    v_exp_f32 v58, v58
    v_exp_f32 v59, v59
    v_exp_f32 v60, v60
    v_exp_f32 v61, v61
    v_exp_f32 v62, v62
    v_exp_f32 v63, v63
    v_exp_f32 v64, v64
    v_exp_f32 v65, v65
    v_exp_f32 v66, v66
    v_exp_f32 v67, v67
    v_exp_f32 v68, v68
    v_exp_f32 v69, v69
    v_exp_f32 v70, v70
    s_setprio 3
    v_exp_f32 v71, v71
    s_waitcnt lgkmcnt(0)
    v_smfmac_f32_32x32x32_bf16 v[164:179], v[124:127], v[56:63], v254
    v_smfmac_f32_32x32x32_bf16 v[164:179], v[128:131], v[64:71], v254
    s_mov_b64 exec, s[92:93]
    ds_read_b128 v[124:127], v14 offset:10240
    ds_read_b128 v[128:131], v14 offset:10752
    s_mov_b64 exec, -1
    v_mfma_f32_32x32x16_bf16 v[56:71], v[180:183], v[120:123], v[24:39]
    ds_read_b128 v[180:183], v13 offset:11264
    s_setprio 0
    v_exp_f32 v40, v40
    s_setprio 2
    v_exp_f32 v41, v41
    v_exp_f32 v42, v42
    v_exp_f32 v43, v43
    v_exp_f32 v44, v44
    v_exp_f32 v45, v45
    v_exp_f32 v46, v46
    v_exp_f32 v47, v47
    v_exp_f32 v48, v48
    v_exp_f32 v49, v49
    v_exp_f32 v50, v50
    v_exp_f32 v51, v51
    v_exp_f32 v52, v52
    v_exp_f32 v53, v53
    v_exp_f32 v54, v54
    s_setprio 3
    v_exp_f32 v55, v55
    s_waitcnt lgkmcnt(0)
    v_smfmac_f32_32x32x32_bf16 v[104:119], v[124:127], v[40:47], v254
    s_add_u32 m0, s84, 0
    s_add_u32 s53, s85, 0
    buffer_load_dwordx4 v17, s[28:31], s53 offen lds
    v_smfmac_f32_32x32x32_bf16 v[104:119], v[128:131], v[48:55], v254
    v_mfma_f32_32x32x16_bf16 v[40:55], v[180:183], v[132:135], v[24:39]
    buffer_load_dwordx2 v[22:23], v253, s[44:47], 0 offen sc1
    s_setprio 0
    v_exp_f32 v56, v56
    s_setprio 2
    v_exp_f32 v57, v57
    v_exp_f32 v58, v58
    v_exp_f32 v59, v59
    v_exp_f32 v60, v60
    v_exp_f32 v61, v61
    v_exp_f32 v62, v62
    v_exp_f32 v63, v63
    v_exp_f32 v64, v64
    v_exp_f32 v65, v65
    v_exp_f32 v66, v66
    v_exp_f32 v67, v67
    v_exp_f32 v68, v68
    v_exp_f32 v69, v69
    v_exp_f32 v70, v70
    s_setprio 3
    v_exp_f32 v71, v71
    s_waitcnt lgkmcnt(0)
    v_smfmac_f32_32x32x32_bf16 v[164:179], v[124:127], v[56:63], v254
    s_add_u32 m0, s84, 1024
    s_add_u32 s53, s85, 8192
    buffer_load_dwordx4 v17, s[28:31], s53 offen lds
    v_smfmac_f32_32x32x32_bf16 v[164:179], v[128:131], v[64:71], v254
    s_mov_b64 exec, s[92:93]
    ds_read_b128 v[124:127], v14 offset:11264
    ds_read_b128 v[128:131], v14 offset:11776
    s_mov_b64 exec, -1
    s_add_u32 m0, s84, 2048
    s_add_u32 s53, s85, 16384
    buffer_load_dwordx4 v17, s[28:31], s53 offen lds
    v_mfma_f32_32x32x16_bf16 v[56:71], v[180:183], v[120:123], v[24:39]
    ds_read_b128 v[180:183], v13 offset:12288
    s_setprio 0
    v_exp_f32 v40, v40
    s_setprio 2
    v_exp_f32 v41, v41
    v_exp_f32 v42, v42
    v_exp_f32 v43, v43
    v_exp_f32 v44, v44
    v_exp_f32 v45, v45
    v_exp_f32 v46, v46
    v_exp_f32 v47, v47
    v_exp_f32 v48, v48
    v_exp_f32 v49, v49
    v_exp_f32 v50, v50
    v_exp_f32 v51, v51
    v_exp_f32 v52, v52
    v_exp_f32 v53, v53
    v_exp_f32 v54, v54
    s_setprio 3
    v_exp_f32 v55, v55
    s_waitcnt lgkmcnt(0)
    v_smfmac_f32_32x32x32_bf16 v[104:119], v[124:127], v[40:47], v254
    s_add_u32 m0, s84, 3072
    s_add_u32 s53, s85, 24576
    buffer_load_dwordx4 v17, s[28:31], s53 offen lds
    v_smfmac_f32_32x32x32_bf16 v[104:119], v[128:131], v[48:55], v254
    v_mfma_f32_32x32x16_bf16 v[40:55], v[180:183], v[132:135], v[24:39]
    s_setprio 0
    v_exp_f32 v56, v56
    s_setprio 2
    v_exp_f32 v57, v57
    v_exp_f32 v58, v58
    v_exp_f32 v59, v59
    v_exp_f32 v60, v60
    v_exp_f32 v61, v61
    v_exp_f32 v62, v62
    v_exp_f32 v63, v63
    v_exp_f32 v64, v64
    v_exp_f32 v65, v65
    v_exp_f32 v66, v66
    v_exp_f32 v67, v67
    v_exp_f32 v68, v68
    v_exp_f32 v69, v69
    v_exp_f32 v70, v70
    s_setprio 3
    v_exp_f32 v71, v71
    s_waitcnt lgkmcnt(0)
    v_smfmac_f32_32x32x32_bf16 v[164:179], v[124:127], v[56:63], v254
    v_smfmac_f32_32x32x32_bf16 v[164:179], v[128:131], v[64:71], v254
    s_mov_b64 exec, s[92:93]
    ds_read_b128 v[124:127], v14 offset:12288
    ds_read_b128 v[128:131], v14 offset:12800
    s_mov_b64 exec, -1
    v_mfma_f32_32x32x16_bf16 v[56:71], v[180:183], v[120:123], v[24:39]
    ds_read_b128 v[180:183], v13 offset:13312
    s_waitcnt vmcnt(3)
    s_mov_b32 s56, 0
L_po13:
    v_cmp_eq_u64 vcc, s[58:59], v[22:23]
    s_nop 0
    s_cmp_eq_u64 vcc, -1
    s_cbranch_scc1 L_pod14
    s_sleep 8
    buffer_load_dwordx2 v[22:23], v253, s[44:47], 0 offen sc1
    s_waitcnt vmcnt(0)
    s_add_u32 s56, s56, 1
    s_cmp_lt_u32 s56, 40000
    s_cbranch_scc1 L_po13
L_pod14:
    s_setprio 0
    v_exp_f32 v40, v40
    s_setprio 2
    v_exp_f32 v41, v41
    v_exp_f32 v42, v42
    v_exp_f32 v43, v43
    v_exp_f32 v44, v44
    v_exp_f32 v45, v45
    v_exp_f32 v46, v46
    v_exp_f32 v47, v47
    v_exp_f32 v48, v48
    v_exp_f32 v49, v49
    v_exp_f32 v50, v50
    v_exp_f32 v51, v51
    v_exp_f32 v52, v52
    v_exp_f32 v53, v53
    v_exp_f32 v54, v54
    s_setprio 3
    v_exp_f32 v55, v55
    s_waitcnt lgkmcnt(0)
    v_smfmac_f32_32x32x32_bf16 v[104:119], v[124:127], v[40:47], v254
    buffer_load_dwordx4 v[148:151], v2, s[44:47], s86 offen offset:0 sc1
    v_smfmac_f32_32x32x32_bf16 v[104:119], v[128:131], v[48:55], v254
    buffer_load_dwordx4 v[152:155], v2, s[44:47], s87 offen offset:0 sc1
    v_mfma_f32_32x32x16_bf16 v[40:55], v[180:183], v[132:135], v[24:39]
    s_setprio 0
    v_exp_f32 v56, v56
    s_setprio 2
    v_exp_f32 v57, v57
    v_exp_f32 v58, v58
    v_exp_f32 v59, v59
    v_exp_f32 v60, v60
    v_exp_f32 v61, v61
    v_exp_f32 v62, v62
    v_exp_f32 v63, v63
    v_exp_f32 v64, v64
    v_exp_f32 v65, v65
    v_exp_f32 v66, v66
    v_exp_f32 v67, v67
    v_exp_f32 v68, v68
    v_exp_f32 v69, v69
    v_exp_f32 v70, v70
    s_setprio 3
    v_exp_f32 v71, v71
    s_waitcnt lgkmcnt(0)
    v_smfmac_f32_32x32x32_bf16 v[164:179], v[124:127], v[56:63], v254
    buffer_load_dwordx4 v[156:159], v2, s[44:47], s86 offen offset:1024 sc1
    v_smfmac_f32_32x32x32_bf16 v[164:179], v[128:131], v[64:71], v254
    s_mov_b64 exec, s[92:93]
    ds_read_b128 v[124:127], v14 offset:13312
    ds_read_b128 v[128:131], v14 offset:13824
    s_mov_b64 exec, -1
    buffer_load_dwordx4 v[160:163], v2, s[44:47], s87 offen offset:1024 sc1
    v_mfma_f32_32x32x16_bf16 v[56:71], v[180:183], v[120:123], v[24:39]
    ds_read_b128 v[180:183], v13 offset:14336
    s_setprio 0
    v_exp_f32 v40, v40
    s_setprio 2
    v_exp_f32 v41, v41
    v_exp_f32 v42, v42
    v_exp_f32 v43, v43
    v_exp_f32 v44, v44
    v_exp_f32 v45, v45
    v_exp_f32 v46, v46
    v_exp_f32 v47, v47
    v_exp_f32 v48, v48
    v_exp_f32 v49, v49
    v_exp_f32 v50, v50
    v_exp_f32 v51, v51
    v_exp_f32 v52, v52
    v_exp_f32 v53, v53
    v_exp_f32 v54, v54
    s_setprio 3
    v_exp_f32 v55, v55
    s_waitcnt lgkmcnt(0)
    v_smfmac_f32_32x32x32_bf16 v[104:119], v[124:127], v[40:47], v254
    buffer_load_dwordx4 v[80:83], v2, s[44:47], s86 offen offset:2048 sc1
    v_smfmac_f32_32x32x32_bf16 v[104:119], v[128:131], v[48:55], v254
    buffer_load_dwordx4 v[84:87], v2, s[44:47], s87 offen offset:2048 sc1
    v_mfma_f32_32x32x16_bf16 v[40:55], v[180:183], v[132:135], v[24:39]
    s_waitcnt vmcnt(8)
    ds_read_b64_tr_b16 v[140:141], v18 offset:0
    ds_read_b64_tr_b16 v[142:143], v18 offset:1024
    ds_read_b64_tr_b16 v[144:145], v19 offset:0
    ds_read_b64_tr_b16 v[146:147], v19 offset:1024
    s_setprio 0
    v_exp_f32 v56, v56
    s_setprio 2
    v_exp_f32 v57, v57
    v_exp_f32 v58, v58
    v_exp_f32 v59, v59
    v_exp_f32 v60, v60
    v_exp_f32 v61, v61
    v_exp_f32 v62, v62
    v_exp_f32 v63, v63
    v_exp_f32 v64, v64
    v_exp_f32 v65, v65
    v_exp_f32 v66, v66
    v_exp_f32 v67, v67
    v_exp_f32 v68, v68
    v_exp_f32 v69, v69
    v_exp_f32 v70, v70
    s_setprio 3
    v_exp_f32 v71, v71
    s_waitcnt lgkmcnt(0)
    v_smfmac_f32_32x32x32_bf16 v[164:179], v[124:127], v[56:63], v254
    s_add_u32 m0, s84, 0
    s_add_u32 s53, s85, 32768
    buffer_load_dwordx4 v17, s[28:31], s53 offen lds
    v_smfmac_f32_32x32x32_bf16 v[164:179], v[128:131], v[64:71], v254
    s_mov_b64 exec, s[92:93]
    ds_read_b128 v[124:127], v14 offset:14336
    ds_read_b128 v[128:131], v14 offset:14848
    s_mov_b64 exec, -1
    s_add_u32 m0, s84, 1024
    s_add_u32 s53, s85, 40960
    buffer_load_dwordx4 v17, s[28:31], s53 offen lds
    v_mfma_f32_32x32x16_bf16 v[56:71], v[180:183], v[120:123], v[24:39]
    ds_read_b128 v[180:183], v13 offset:15360
    s_waitcnt vmcnt(7)
    v_mfma_f32_32x32x16_bf16 v[184:199], v[140:143], v[148:151], 0
    v_mfma_f32_32x32x16_bf16 v[200:215], v[144:147], v[148:151], 0
    s_setprio 0
    v_exp_f32 v40, v40
    s_setprio 2
    v_exp_f32 v41, v41
    v_exp_f32 v42, v42
    v_exp_f32 v43, v43
    v_exp_f32 v44, v44
    v_exp_f32 v45, v45
    v_exp_f32 v46, v46
    v_exp_f32 v47, v47
    v_exp_f32 v48, v48
    v_exp_f32 v49, v49
    v_exp_f32 v50, v50
    v_exp_f32 v51, v51
    v_exp_f32 v52, v52
    v_exp_f32 v53, v53
    v_exp_f32 v54, v54
    s_setprio 3
    v_exp_f32 v55, v55
    s_waitcnt lgkmcnt(0)
    v_smfmac_f32_32x32x32_bf16 v[104:119], v[124:127], v[40:47], v254
    buffer_load_dwordx4 v[88:91], v2, s[44:47], s86 offen offset:3072 sc1
    v_smfmac_f32_32x32x32_bf16 v[104:119], v[128:131], v[48:55], v254
    buffer_load_dwordx4 v[92:95], v2, s[44:47], s87 offen offset:3072 sc1
    v_mfma_f32_32x32x16_bf16 v[40:55], v[180:183], v[132:135], v[24:39]
    ds_read_b64_tr_b16 v[96:97], v18 offset:2048
    ds_read_b64_tr_b16 v[98:99], v18 offset:3072
    ds_read_b64_tr_b16 v[100:101], v19 offset:2048
    ds_read_b64_tr_b16 v[102:103], v19 offset:3072
    s_waitcnt vmcnt(8)
    v_mfma_f32_32x32x16_bf16 v[216:231], v[140:143], v[152:155], 0
    v_mfma_f32_32x32x16_bf16 v[232:247], v[144:147], v[152:155], 0
    s_setprio 0
    v_exp_f32 v56, v56
    s_setprio 2
    v_exp_f32 v57, v57
    v_exp_f32 v58, v58
    v_exp_f32 v59, v59
    v_exp_f32 v60, v60
    v_exp_f32 v61, v61
    v_exp_f32 v62, v62
    v_exp_f32 v63, v63
    v_exp_f32 v64, v64
    v_exp_f32 v65, v65
    v_exp_f32 v66, v66
    v_exp_f32 v67, v67
    v_exp_f32 v68, v68
    v_exp_f32 v69, v69
    v_exp_f32 v70, v70
    s_setprio 3
    v_exp_f32 v71, v71
    s_waitcnt lgkmcnt(0)
    v_smfmac_f32_32x32x32_bf16 v[164:179], v[124:127], v[56:63], v254
    s_add_u32 m0, s84, 2048
    s_add_u32 s53, s85, 49152
    buffer_load_dwordx4 v17, s[28:31], s53 offen lds
    v_smfmac_f32_32x32x32_bf16 v[164:179], v[128:131], v[64:71], v254
    s_mov_b64 exec, s[92:93]
    ds_read_b128 v[124:127], v14 offset:15360
    ds_read_b128 v[128:131], v14 offset:15872
    s_mov_b64 exec, -1
    s_add_u32 m0, s84, 3072
    s_add_u32 s53, s85, 57344
    buffer_load_dwordx4 v17, s[28:31], s53 offen lds
    v_mfma_f32_32x32x16_bf16 v[56:71], v[180:183], v[120:123], v[24:39]
    ds_read_b128 v[180:183], v13 offset:16384
    v_bfe_u32 v3, v1, 3, 2
    v_and_b32 v4, 7, v1
    v_lshlrev_b32 v4, 2, v4
    v_lshl_add_u32 v3, v3, 7, v4
    buffer_load_dword v15, v3, s[44:47], s99 offen sc1
    buffer_load_dword v16, v3, s[44:47], s100 offen sc1
    s_waitcnt vmcnt(11)
    v_mfma_f32_32x32x16_bf16 v[184:199], v[96:99], v[156:159], v[184:199]
    v_mfma_f32_32x32x16_bf16 v[200:215], v[100:103], v[156:159], v[200:215]
    s_setprio 0
    v_exp_f32 v40, v40
    s_setprio 2
    v_exp_f32 v41, v41
    v_exp_f32 v42, v42
    v_exp_f32 v43, v43
    v_exp_f32 v44, v44
    v_exp_f32 v45, v45
    v_exp_f32 v46, v46
    v_exp_f32 v47, v47
    v_exp_f32 v48, v48
    v_exp_f32 v49, v49
    v_exp_f32 v50, v50
    v_exp_f32 v51, v51
    v_exp_f32 v52, v52
    v_exp_f32 v53, v53
    v_exp_f32 v54, v54
    s_setprio 3
    v_exp_f32 v55, v55
    s_waitcnt lgkmcnt(0)
    v_smfmac_f32_32x32x32_bf16 v[104:119], v[124:127], v[40:47], v254
    s_add_u32 s86, s86, 4096
    buffer_load_dwordx4 v[148:151], v2, s[44:47], s86 offen offset:0 sc1
    v_smfmac_f32_32x32x32_bf16 v[104:119], v[128:131], v[48:55], v254
    s_add_u32 s87, s87, 4096
    buffer_load_dwordx4 v[152:155], v2, s[44:47], s87 offen offset:0 sc1
    v_mfma_f32_32x32x16_bf16 v[40:55], v[180:183], v[132:135], v[24:39]
    s_waitcnt vmcnt(8)
    ds_read_b64_tr_b16 v[140:141], v18 offset:0
    ds_read_b64_tr_b16 v[142:143], v18 offset:1024
    ds_read_b64_tr_b16 v[144:145], v19 offset:0
    ds_read_b64_tr_b16 v[146:147], v19 offset:1024
    v_mfma_f32_32x32x16_bf16 v[216:231], v[96:99], v[160:163], v[216:231]
    v_mfma_f32_32x32x16_bf16 v[232:247], v[100:103], v[160:163], v[232:247]
    s_setprio 0
    v_exp_f32 v56, v56
    s_setprio 2
    v_exp_f32 v57, v57
    v_exp_f32 v58, v58
    v_exp_f32 v59, v59
    v_exp_f32 v60, v60
    v_exp_f32 v61, v61
    v_exp_f32 v62, v62
    v_exp_f32 v63, v63
    v_exp_f32 v64, v64
    v_exp_f32 v65, v65
    v_exp_f32 v66, v66
    v_exp_f32 v67, v67
    v_exp_f32 v68, v68
    v_exp_f32 v69, v69
    v_exp_f32 v70, v70
    s_setprio 3
    v_exp_f32 v71, v71
    s_waitcnt lgkmcnt(0)
    v_smfmac_f32_32x32x32_bf16 v[164:179], v[124:127], v[56:63], v254
    s_add_u32 m0, s84, 0
    s_add_u32 s53, s85, 65536
    buffer_load_dwordx4 v17, s[28:31], s53 offen lds
    v_smfmac_f32_32x32x32_bf16 v[164:179], v[128:131], v[64:71], v254
    s_mov_b64 exec, s[92:93]
    ds_read_b128 v[124:127], v14 offset:16384
    ds_read_b128 v[128:131], v14 offset:16896
    s_mov_b64 exec, -1
    s_add_u32 m0, s84, 1024
    s_add_u32 s53, s85, 73728
    buffer_load_dwordx4 v17, s[28:31], s53 offen lds
    v_mfma_f32_32x32x16_bf16 v[56:71], v[180:183], v[120:123], v[24:39]
    ds_read_b128 v[180:183], v13 offset:17408
    v_mfma_f32_32x32x16_bf16 v[184:199], v[140:143], v[80:83], v[184:199]
    v_mfma_f32_32x32x16_bf16 v[200:215], v[144:147], v[80:83], v[200:215]
    s_setprio 0
    v_exp_f32 v40, v40
    s_setprio 2
    v_exp_f32 v41, v41
    v_exp_f32 v42, v42
    v_exp_f32 v43, v43
    v_exp_f32 v44, v44
    v_exp_f32 v45, v45
    v_exp_f32 v46, v46
    v_exp_f32 v47, v47
    v_exp_f32 v48, v48
    v_exp_f32 v49, v49
    v_exp_f32 v50, v50
    v_exp_f32 v51, v51
    v_exp_f32 v52, v52
    v_exp_f32 v53, v53
    v_exp_f32 v54, v54
    s_setprio 3
    v_exp_f32 v55, v55
    s_waitcnt lgkmcnt(0)
    v_smfmac_f32_32x32x32_bf16 v[104:119], v[124:127], v[40:47], v254
    buffer_load_dwordx4 v[156:159], v2, s[44:47], s86 offen offset:1024 sc1
    v_smfmac_f32_32x32x32_bf16 v[104:119], v[128:131], v[48:55], v254
    buffer_load_dwordx4 v[160:163], v2, s[44:47], s87 offen offset:1024 sc1
    v_mfma_f32_32x32x16_bf16 v[40:55], v[180:183], v[132:135], v[24:39]
    s_waitcnt vmcnt(8)
    ds_read_b64_tr_b16 v[96:97], v18 offset:2048
    ds_read_b64_tr_b16 v[98:99], v18 offset:3072
    ds_read_b64_tr_b16 v[100:101], v19 offset:2048
    ds_read_b64_tr_b16 v[102:103], v19 offset:3072
    v_mfma_f32_32x32x16_bf16 v[216:231], v[140:143], v[84:87], v[216:231]
    v_mfma_f32_32x32x16_bf16 v[232:247], v[144:147], v[84:87], v[232:247]
    s_setprio 0
    v_exp_f32 v56, v56
    s_setprio 2
    v_exp_f32 v57, v57
    v_exp_f32 v58, v58
    v_exp_f32 v59, v59
    v_exp_f32 v60, v60
    v_exp_f32 v61, v61
    v_exp_f32 v62, v62
    v_exp_f32 v63, v63
    v_exp_f32 v64, v64
    v_exp_f32 v65, v65
    v_exp_f32 v66, v66
    v_exp_f32 v67, v67
    v_exp_f32 v68, v68
    v_exp_f32 v69, v69
    v_exp_f32 v70, v70
    s_setprio 3
    v_exp_f32 v71, v71
    s_waitcnt lgkmcnt(0)
    v_smfmac_f32_32x32x32_bf16 v[164:179], v[124:127], v[56:63], v254
    s_add_u32 m0, s84, 2048
    s_add_u32 s53, s85, 81920
    buffer_load_dwordx4 v17, s[28:31], s53 offen lds
    v_smfmac_f32_32x32x32_bf16 v[164:179], v[128:131], v[64:71], v254
    s_mov_b64 exec, s[92:93]
    ds_read_b128 v[124:127], v14 offset:17408
    ds_read_b128 v[128:131], v14 offset:17920
    s_mov_b64 exec, -1
    s_add_u32 m0, s84, 3072
    s_add_u32 s53, s85, 90112
    buffer_load_dwordx4 v17, s[28:31], s53 offen lds
    v_mfma_f32_32x32x16_bf16 v[56:71], v[180:183], v[120:123], v[24:39]
    ds_read_b128 v[180:183], v13 offset:18432
    v_mfma_f32_32x32x16_bf16 v[184:199], v[96:99], v[88:91], v[184:199]
    v_mfma_f32_32x32x16_bf16 v[200:215], v[100:103], v[88:91], v[200:215]
    s_setprio 0
    v_exp_f32 v40, v40
    s_setprio 2
    v_exp_f32 v41, v41
    v_exp_f32 v42, v42
    v_exp_f32 v43, v43
    v_exp_f32 v44, v44
    v_exp_f32 v45, v45
    v_exp_f32 v46, v46
    v_exp_f32 v47, v47
    v_exp_f32 v48, v48
    v_exp_f32 v49, v49
    v_exp_f32 v50, v50
    v_exp_f32 v51, v51
    v_exp_f32 v52, v52
    v_exp_f32 v53, v53
    v_exp_f32 v54, v54
    s_setprio 3
    v_exp_f32 v55, v55
    s_waitcnt lgkmcnt(0)
    v_smfmac_f32_32x32x32_bf16 v[104:119], v[124:127], v[40:47], v254
    buffer_load_dwordx4 v[80:83], v2, s[44:47], s86 offen offset:2048 sc1
    v_smfmac_f32_32x32x32_bf16 v[104:119], v[128:131], v[48:55], v254
    buffer_load_dwordx4 v[84:87], v2, s[44:47], s87 offen offset:2048 sc1
    v_mfma_f32_32x32x16_bf16 v[40:55], v[180:183], v[132:135], v[24:39]
    s_waitcnt vmcnt(6)
    ds_read_b64_tr_b16 v[140:141], v18 offset:0
    ds_read_b64_tr_b16 v[142:143], v18 offset:1024
    ds_read_b64_tr_b16 v[144:145], v19 offset:0
    ds_read_b64_tr_b16 v[146:147], v19 offset:1024
    v_mfma_f32_32x32x16_bf16 v[216:231], v[96:99], v[92:95], v[216:231]
    v_mfma_f32_32x32x16_bf16 v[232:247], v[100:103], v[92:95], v[232:247]
    s_setprio 0
    v_exp_f32 v56, v56
    s_setprio 2
    v_exp_f32 v57, v57
    v_exp_f32 v58, v58
    v_exp_f32 v59, v59
    v_exp_f32 v60, v60
    v_exp_f32 v61, v61
    v_exp_f32 v62, v62
    v_exp_f32 v63, v63
    v_exp_f32 v64, v64
    v_exp_f32 v65, v65
    v_exp_f32 v66, v66
    v_exp_f32 v67, v67
    v_exp_f32 v68, v68
    v_exp_f32 v69, v69
    v_exp_f32 v70, v70
    s_setprio 3
    v_exp_f32 v71, v71
    s_waitcnt lgkmcnt(0)
    v_smfmac_f32_32x32x32_bf16 v[164:179], v[124:127], v[56:63], v254
    s_add_u32 m0, s84, 0
    s_add_u32 s53, s85, 98304
    buffer_load_dwordx4 v17, s[28:31], s53 offen lds
    v_smfmac_f32_32x32x32_bf16 v[164:179], v[128:131], v[64:71], v254
    s_mov_b64 exec, s[92:93]
    ds_read_b128 v[124:127], v14 offset:18432
    ds_read_b128 v[128:131], v14 offset:18944
    s_mov_b64 exec, -1
    s_add_u32 m0, s84, 1024
    s_add_u32 s53, s85, 106496
    buffer_load_dwordx4 v17, s[28:31], s53 offen lds
    v_mfma_f32_32x32x16_bf16 v[56:71], v[180:183], v[120:123], v[24:39]
    ds_read_b128 v[180:183], v13 offset:19456
    v_mfma_f32_32x32x16_bf16 v[184:199], v[140:143], v[148:151], v[184:199]
    v_mfma_f32_32x32x16_bf16 v[200:215], v[144:147], v[148:151], v[200:215]
    s_setprio 0
    v_exp_f32 v40, v40
    s_setprio 2
    v_exp_f32 v41, v41
    v_exp_f32 v42, v42
    v_exp_f32 v43, v43
    v_exp_f32 v44, v44
    v_exp_f32 v45, v45
    v_exp_f32 v46, v46
    v_exp_f32 v47, v47
    v_exp_f32 v48, v48
    v_exp_f32 v49, v49
    v_exp_f32 v50, v50
    v_exp_f32 v51, v51
    v_exp_f32 v52, v52
    v_exp_f32 v53, v53
    v_exp_f32 v54, v54
    s_setprio 3
    v_exp_f32 v55, v55
    s_waitcnt lgkmcnt(0)
    v_smfmac_f32_32x32x32_bf16 v[104:119], v[124:127], v[40:47], v254
    buffer_load_dwordx4 v[88:91], v2, s[44:47], s86 offen offset:3072 sc1
    v_smfmac_f32_32x32x32_bf16 v[104:119], v[128:131], v[48:55], v254
    buffer_load_dwordx4 v[92:95], v2, s[44:47], s87 offen offset:3072 sc1
    v_mfma_f32_32x32x16_bf16 v[40:55], v[180:183], v[132:135], v[24:39]
    v_mfma_f32_32x32x16_bf16 v[216:231], v[140:143], v[152:155], v[216:231]
    s_setprio 0
    v_exp_f32 v56, v56
    s_setprio 2
    v_exp_f32 v57, v57
    v_exp_f32 v58, v58
    v_exp_f32 v59, v59
    v_exp_f32 v60, v60
    v_exp_f32 v61, v61
    v_exp_f32 v62, v62
    v_exp_f32 v63, v63
    v_exp_f32 v64, v64
    v_exp_f32 v65, v65
    v_exp_f32 v66, v66
    v_exp_f32 v67, v67
    v_exp_f32 v68, v68
    v_exp_f32 v69, v69
    v_exp_f32 v70, v70
    s_setprio 3
    v_exp_f32 v71, v71
    s_waitcnt lgkmcnt(0)
    v_smfmac_f32_32x32x32_bf16 v[164:179], v[124:127], v[56:63], v254
    v_smfmac_f32_32x32x32_bf16 v[164:179], v[128:131], v[64:71], v254
    s_mov_b64 exec, s[92:93]
    ds_read_b128 v[124:127], v14 offset:19456
    ds_read_b128 v[128:131], v14 offset:19968
    s_mov_b64 exec, -1
    v_mfma_f32_32x32x16_bf16 v[56:71], v[180:183], v[120:123], v[24:39]
    ds_read_b128 v[180:183], v13 offset:20480
    s_waitcnt vmcnt(6)
    ds_read_b64_tr_b16 v[96:97], v18 offset:2048
    ds_read_b64_tr_b16 v[98:99], v18 offset:3072
    ds_read_b64_tr_b16 v[100:101], v19 offset:2048
    ds_read_b64_tr_b16 v[102:103], v19 offset:3072
    v_mfma_f32_32x32x16_bf16 v[232:247], v[144:147], v[152:155], v[232:247]
    s_setprio 0
    v_exp_f32 v40, v40
    s_setprio 2
    v_exp_f32 v41, v41
    v_exp_f32 v42, v42
    v_exp_f32 v43, v43
    v_exp_f32 v44, v44
    v_exp_f32 v45, v45
    v_exp_f32 v46, v46
    v_exp_f32 v47, v47
    v_exp_f32 v48, v48
    v_exp_f32 v49, v49
    v_exp_f32 v50, v50
    v_exp_f32 v51, v51
    v_exp_f32 v52, v52
    v_exp_f32 v53, v53
    v_exp_f32 v54, v54
    s_setprio 3
    v_exp_f32 v55, v55
    s_waitcnt lgkmcnt(0)
    v_smfmac_f32_32x32x32_bf16 v[104:119], v[124:127], v[40:47], v254
    s_add_u32 m0, s84, 2048
    s_add_u32 s53, s85, 114688
    buffer_load_dwordx4 v17, s[28:31], s53 offen lds
    v_smfmac_f32_32x32x32_bf16 v[104:119], v[128:131], v[48:55], v254
    s_add_u32 m0, s84, 3072
    s_add_u32 s53, s85, 122880
    buffer_load_dwordx4 v17, s[28:31], s53 offen lds
    v_mfma_f32_32x32x16_bf16 v[40:55], v[180:183], v[132:135], v[24:39]
    v_mfma_f32_32x32x16_bf16 v[184:199], v[96:99], v[156:159], v[184:199]
    v_mfma_f32_32x32x16_bf16 v[200:215], v[100:103], v[156:159], v[200:215]
    s_setprio 0
    v_exp_f32 v56, v56
    s_setprio 2
    v_exp_f32 v57, v57
    v_exp_f32 v58, v58
    v_exp_f32 v59, v59
    v_exp_f32 v60, v60
    v_exp_f32 v61, v61
    v_exp_f32 v62, v62
    v_exp_f32 v63, v63
    v_exp_f32 v64, v64
    v_exp_f32 v65, v65
    v_exp_f32 v66, v66
    v_exp_f32 v67, v67
    v_exp_f32 v68, v68
    v_exp_f32 v69, v69
    v_exp_f32 v70, v70
    s_setprio 3
    v_exp_f32 v71, v71
    s_waitcnt lgkmcnt(0)
    v_smfmac_f32_32x32x32_bf16 v[164:179], v[124:127], v[56:63], v254
    s_add_u32 s86, s86, 4096
    buffer_load_dwordx4 v[148:151], v2, s[44:47], s86 offen offset:0 sc1
    v_smfmac_f32_32x32x32_bf16 v[164:179], v[128:131], v[64:71], v254
    s_mov_b64 exec, s[92:93]
    ds_read_b128 v[124:127], v14 offset:20480
    ds_read_b128 v[128:131], v14 offset:20992
    s_mov_b64 exec, -1
    s_add_u32 s87, s87, 4096
    buffer_load_dwordx4 v[152:155], v2, s[44:47], s87 offen offset:0 sc1
    v_mfma_f32_32x32x16_bf16 v[56:71], v[180:183], v[120:123], v[24:39]
    ds_read_b128 v[180:183], v13 offset:21504
    s_waitcnt vmcnt(6)
    ds_read_b64_tr_b16 v[140:141], v18 offset:0
    ds_read_b64_tr_b16 v[142:143], v18 offset:1024
    ds_read_b64_tr_b16 v[144:145], v19 offset:0
    ds_read_b64_tr_b16 v[146:147], v19 offset:1024
    v_mfma_f32_32x32x16_bf16 v[216:231], v[96:99], v[160:163], v[216:231]
    v_mfma_f32_32x32x16_bf16 v[232:247], v[100:103], v[160:163], v[232:247]
    s_setprio 0
    v_exp_f32 v40, v40
    s_setprio 2
    v_exp_f32 v41, v41
    v_exp_f32 v42, v42
    v_exp_f32 v43, v43
    v_exp_f32 v44, v44
    v_exp_f32 v45, v45
    v_exp_f32 v46, v46
    v_exp_f32 v47, v47
    v_exp_f32 v48, v48
    v_exp_f32 v49, v49
    v_exp_f32 v50, v50
    v_exp_f32 v51, v51
    v_exp_f32 v52, v52
    v_exp_f32 v53, v53
    v_exp_f32 v54, v54
    s_setprio 3
    v_exp_f32 v55, v55
    s_waitcnt lgkmcnt(0)
    v_smfmac_f32_32x32x32_bf16 v[104:119], v[124:127], v[40:47], v254
    s_add_u32 m0, s84, 0
    s_add_u32 s53, s85, 131072
    buffer_load_dwordx4 v17, s[28:31], s53 offen lds
    v_smfmac_f32_32x32x32_bf16 v[104:119], v[128:131], v[48:55], v254
    s_add_u32 m0, s84, 1024
    s_add_u32 s53, s85, 139264
    buffer_load_dwordx4 v17, s[28:31], s53 offen lds
    v_mfma_f32_32x32x16_bf16 v[40:55], v[180:183], v[132:135], v[24:39]
    v_mfma_f32_32x32x16_bf16 v[184:199], v[140:143], v[80:83], v[184:199]
    v_mfma_f32_32x32x16_bf16 v[200:215], v[144:147], v[80:83], v[200:215]
    s_setprio 0
    v_exp_f32 v56, v56
    s_setprio 2
    v_exp_f32 v57, v57
    v_exp_f32 v58, v58
    v_exp_f32 v59, v59
    v_exp_f32 v60, v60
    v_exp_f32 v61, v61
    v_exp_f32 v62, v62
    v_exp_f32 v63, v63
    v_exp_f32 v64, v64
    v_exp_f32 v65, v65
    v_exp_f32 v66, v66
    v_exp_f32 v67, v67
    v_exp_f32 v68, v68
    v_exp_f32 v69, v69
    v_exp_f32 v70, v70
    s_setprio 3
    v_exp_f32 v71, v71
    s_waitcnt lgkmcnt(0)
    v_smfmac_f32_32x32x32_bf16 v[164:179], v[124:127], v[56:63], v254
    buffer_load_dwordx4 v[156:159], v2, s[44:47], s86 offen offset:1024 sc1
    v_smfmac_f32_32x32x32_bf16 v[164:179], v[128:131], v[64:71], v254
    s_mov_b64 exec, s[92:93]
    ds_read_b128 v[124:127], v14 offset:21504
    ds_read_b128 v[128:131], v14 offset:22016
    s_mov_b64 exec, -1
    buffer_load_dwordx4 v[160:163], v2, s[44:47], s87 offen offset:1024 sc1
    v_mfma_f32_32x32x16_bf16 v[56:71], v[180:183], v[120:123], v[24:39]
    ds_read_b128 v[180:183], v13 offset:22528
    s_waitcnt vmcnt(6)
    ds_read_b64_tr_b16 v[96:97], v18 offset:2048
    ds_read_b64_tr_b16 v[98:99], v18 offset:3072
    ds_read_b64_tr_b16 v[100:101], v19 offset:2048
    ds_read_b64_tr_b16 v[102:103], v19 offset:3072
    v_mfma_f32_32x32x16_bf16 v[216:231], v[140:143], v[84:87], v[216:231]
    v_mfma_f32_32x32x16_bf16 v[232:247], v[144:147], v[84:87], v[232:247]
    s_setprio 0
    v_exp_f32 v40, v40
    s_setprio 2
    v_exp_f32 v41, v41
    v_exp_f32 v42, v42
    v_exp_f32 v43, v43
    v_exp_f32 v44, v44
    v_exp_f32 v45, v45
    v_exp_f32 v46, v46
    v_exp_f32 v47, v47
    v_exp_f32 v48, v48
    v_exp_f32 v49, v49
    v_exp_f32 v50, v50
    v_exp_f32 v51, v51
    v_exp_f32 v52, v52
    v_exp_f32 v53, v53
    v_exp_f32 v54, v54
    s_setprio 3
    v_exp_f32 v55, v55
    s_waitcnt lgkmcnt(0)
    v_smfmac_f32_32x32x32_bf16 v[104:119], v[124:127], v[40:47], v254
    s_add_u32 m0, s84, 2048
    s_add_u32 s53, s85, 147456
    buffer_load_dwordx4 v17, s[28:31], s53 offen lds
    v_smfmac_f32_32x32x32_bf16 v[104:119], v[128:131], v[48:55], v254
    s_add_u32 m0, s84, 3072
    s_add_u32 s53, s85, 155648
    buffer_load_dwordx4 v17, s[28:31], s53 offen lds
    v_mfma_f32_32x32x16_bf16 v[40:55], v[180:183], v[132:135], v[24:39]
    v_mfma_f32_32x32x16_bf16 v[184:199], v[96:99], v[88:91], v[184:199]
    v_mfma_f32_32x32x16_bf16 v[200:215], v[100:103], v[88:91], v[200:215]
    s_setprio 0
    v_exp_f32 v56, v56
    s_setprio 2
    v_exp_f32 v57, v57
    v_exp_f32 v58, v58
    v_exp_f32 v59, v59
    v_exp_f32 v60, v60
    v_exp_f32 v61, v61
    v_exp_f32 v62, v62
    v_exp_f32 v63, v63
    v_exp_f32 v64, v64
    v_exp_f32 v65, v65
    v_exp_f32 v66, v66
    v_exp_f32 v67, v67
    v_exp_f32 v68, v68
    v_exp_f32 v69, v69
    v_exp_f32 v70, v70
    s_setprio 3
    v_exp_f32 v71, v71
    s_waitcnt lgkmcnt(0)
    v_smfmac_f32_32x32x32_bf16 v[164:179], v[124:127], v[56:63], v254
    buffer_load_dwordx4 v[80:83], v2, s[44:47], s86 offen offset:2048 sc1
    v_smfmac_f32_32x32x32_bf16 v[164:179], v[128:131], v[64:71], v254
    s_mov_b64 exec, s[92:93]
    ds_read_b128 v[124:127], v14 offset:22528
    ds_read_b128 v[128:131], v14 offset:23040
    s_mov_b64 exec, -1
    buffer_load_dwordx4 v[84:87], v2, s[44:47], s87 offen offset:2048 sc1
    v_mfma_f32_32x32x16_bf16 v[56:71], v[180:183], v[120:123], v[24:39]
    ds_read_b128 v[180:183], v13 offset:23552
    s_waitcnt vmcnt(6)
    ds_read_b64_tr_b16 v[140:141], v18 offset:0
    ds_read_b64_tr_b16 v[142:143], v18 offset:1024
    ds_read_b64_tr_b16 v[144:145], v19 offset:0
    ds_read_b64_tr_b16 v[146:147], v19 offset:1024
    v_mfma_f32_32x32x16_bf16 v[216:231], v[96:99], v[92:95], v[216:231]
    v_mfma_f32_32x32x16_bf16 v[232:247], v[100:103], v[92:95], v[232:247]
    s_setprio 0
    v_exp_f32 v40, v40
    s_setprio 2
    v_exp_f32 v41, v41
    v_exp_f32 v42, v42
    v_exp_f32 v43, v43
    v_exp_f32 v44, v44
    v_exp_f32 v45, v45
    v_exp_f32 v46, v46
    v_exp_f32 v47, v47
    v_exp_f32 v48, v48
    v_exp_f32 v49, v49
    v_exp_f32 v50, v50
    v_exp_f32 v51, v51
    v_exp_f32 v52, v52
    v_exp_f32 v53, v53
    v_exp_f32 v54, v54
    s_setprio 3
    v_exp_f32 v55, v55
    s_waitcnt lgkmcnt(0)
    v_smfmac_f32_32x32x32_bf16 v[104:119], v[124:127], v[40:47], v254
    s_add_u32 m0, s84, 0
    s_add_u32 s53, s85, 163840
    buffer_load_dwordx4 v17, s[28:31], s53 offen lds
    v_smfmac_f32_32x32x32_bf16 v[104:119], v[128:131], v[48:55], v254
    s_add_u32 m0, s84, 1024
    s_add_u32 s53, s85, 172032
    buffer_load_dwordx4 v17, s[28:31], s53 offen lds
    v_mfma_f32_32x32x16_bf16 v[40:55], v[180:183], v[132:135], v[24:39]
    v_mfma_f32_32x32x16_bf16 v[184:199], v[140:143], v[148:151], v[184:199]
    v_mfma_f32_32x32x16_bf16 v[200:215], v[144:147], v[148:151], v[200:215]
    s_setprio 0
    v_exp_f32 v56, v56
    s_setprio 2
    v_exp_f32 v57, v57
    v_exp_f32 v58, v58
    v_exp_f32 v59, v59
    v_exp_f32 v60, v60
    v_exp_f32 v61, v61
    v_exp_f32 v62, v62
    v_exp_f32 v63, v63
    v_exp_f32 v64, v64
    v_exp_f32 v65, v65
    v_exp_f32 v66, v66
    v_exp_f32 v67, v67
    v_exp_f32 v68, v68
    v_exp_f32 v69, v69
    v_exp_f32 v70, v70
    s_setprio 3
    v_exp_f32 v71, v71
    s_waitcnt lgkmcnt(0)
    v_smfmac_f32_32x32x32_bf16 v[164:179], v[124:127], v[56:63], v254
    buffer_load_dwordx4 v[88:91], v2, s[44:47], s86 offen offset:3072 sc1
    v_smfmac_f32_32x32x32_bf16 v[164:179], v[128:131], v[64:71], v254
    s_mov_b64 exec, s[92:93]
    ds_read_b128 v[124:127], v14 offset:23552
    ds_read_b128 v[128:131], v14 offset:24064
    s_mov_b64 exec, -1
    buffer_load_dwordx4 v[92:95], v2, s[44:47], s87 offen offset:3072 sc1
    v_mfma_f32_32x32x16_bf16 v[56:71], v[180:183], v[120:123], v[24:39]
    ds_read_b128 v[180:183], v13 offset:24576
    s_waitcnt vmcnt(6)
    ds_read_b64_tr_b16 v[96:97], v18 offset:2048
    ds_read_b64_tr_b16 v[98:99], v18 offset:3072
    ds_read_b64_tr_b16 v[100:101], v19 offset:2048
    ds_read_b64_tr_b16 v[102:103], v19 offset:3072
    v_mfma_f32_32x32x16_bf16 v[216:231], v[140:143], v[152:155], v[216:231]
    v_mfma_f32_32x32x16_bf16 v[232:247], v[144:147], v[152:155], v[232:247]
    s_setprio 0
    v_exp_f32 v40, v40
    s_setprio 2
    v_exp_f32 v41, v41
    v_exp_f32 v42, v42
    v_exp_f32 v43, v43
    v_exp_f32 v44, v44
    v_exp_f32 v45, v45
    v_exp_f32 v46, v46
    v_exp_f32 v47, v47
    v_exp_f32 v48, v48
    v_exp_f32 v49, v49
    v_exp_f32 v50, v50
    v_exp_f32 v51, v51
    v_exp_f32 v52, v52
    v_exp_f32 v53, v53
    v_exp_f32 v54, v54
    s_setprio 3
    v_exp_f32 v55, v55
    s_waitcnt lgkmcnt(0)
    v_smfmac_f32_32x32x32_bf16 v[104:119], v[124:127], v[40:47], v254
    s_add_u32 m0, s84, 2048
    s_add_u32 s53, s85, 180224
    buffer_load_dwordx4 v17, s[28:31], s53 offen lds
    v_smfmac_f32_32x32x32_bf16 v[104:119], v[128:131], v[48:55], v254
    s_add_u32 m0, s84, 3072
    s_add_u32 s53, s85, 188416
    buffer_load_dwordx4 v17, s[28:31], s53 offen lds
    v_mfma_f32_32x32x16_bf16 v[40:55], v[180:183], v[132:135], v[24:39]
    v_mfma_f32_32x32x16_bf16 v[184:199], v[96:99], v[156:159], v[184:199]
    v_mfma_f32_32x32x16_bf16 v[200:215], v[100:103], v[156:159], v[200:215]
    s_setprio 0
    v_exp_f32 v56, v56
    s_setprio 2
    v_exp_f32 v57, v57
    v_exp_f32 v58, v58
    v_exp_f32 v59, v59
    v_exp_f32 v60, v60
    v_exp_f32 v61, v61
    v_exp_f32 v62, v62
    v_exp_f32 v63, v63
    v_exp_f32 v64, v64
    v_exp_f32 v65, v65
    v_exp_f32 v66, v66
    v_exp_f32 v67, v67
    v_exp_f32 v68, v68
    v_exp_f32 v69, v69
    v_exp_f32 v70, v70
    s_setprio 3
    v_exp_f32 v71, v71
    s_waitcnt lgkmcnt(0)
    v_smfmac_f32_32x32x32_bf16 v[164:179], v[124:127], v[56:63], v254
    s_add_u32 s86, s86, 4096
    buffer_load_dwordx4 v[148:151], v2, s[44:47], s86 offen offset:0 sc1
    v_smfmac_f32_32x32x32_bf16 v[164:179], v[128:131], v[64:71], v254
    s_mov_b64 exec, s[92:93]
    ds_read_b128 v[124:127], v14 offset:24576
    ds_read_b128 v[128:131], v14 offset:25088
    s_mov_b64 exec, -1
    s_add_u32 s87, s87, 4096
    buffer_load_dwordx4 v[152:155], v2, s[44:47], s87 offen offset:0 sc1
    v_mfma_f32_32x32x16_bf16 v[56:71], v[180:183], v[120:123], v[24:39]
    ds_read_b128 v[180:183], v13 offset:25600
    v_mfma_f32_32x32x16_bf16 v[216:231], v[96:99], v[160:163], v[216:231]
    s_setprio 0
    v_exp_f32 v40, v40
    s_setprio 2
    v_exp_f32 v41, v41
    v_exp_f32 v42, v42
    v_exp_f32 v43, v43
    v_exp_f32 v44, v44
    v_exp_f32 v45, v45
    v_exp_f32 v46, v46
    v_exp_f32 v47, v47
    v_exp_f32 v48, v48
    v_exp_f32 v49, v49
    v_exp_f32 v50, v50
    v_exp_f32 v51, v51
    v_exp_f32 v52, v52
    v_exp_f32 v53, v53
    v_exp_f32 v54, v54
    s_setprio 3
    v_exp_f32 v55, v55
    s_waitcnt lgkmcnt(0)
    v_smfmac_f32_32x32x32_bf16 v[104:119], v[124:127], v[40:47], v254
    v_smfmac_f32_32x32x32_bf16 v[104:119], v[128:131], v[48:55], v254
    v_mfma_f32_32x32x16_bf16 v[40:55], v[180:183], v[132:135], v[24:39]
    s_waitcnt vmcnt(6)
    ds_read_b64_tr_b16 v[140:141], v18 offset:0
    ds_read_b64_tr_b16 v[142:143], v18 offset:1024
    ds_read_b64_tr_b16 v[144:145], v19 offset:0
    ds_read_b64_tr_b16 v[146:147], v19 offset:1024
    v_mfma_f32_32x32x16_bf16 v[232:247], v[100:103], v[160:163], v[232:247]
    s_setprio 0
    v_exp_f32 v56, v56
    s_setprio 2
    v_exp_f32 v57, v57
    v_exp_f32 v58, v58
    v_exp_f32 v59, v59
    v_exp_f32 v60, v60
    v_exp_f32 v61, v61
    v_exp_f32 v62, v62
    v_exp_f32 v63, v63
    v_exp_f32 v64, v64
    v_exp_f32 v65, v65
    v_exp_f32 v66, v66
    v_exp_f32 v67, v67
    v_exp_f32 v68, v68
    v_exp_f32 v69, v69
    v_exp_f32 v70, v70
    s_setprio 3
    v_exp_f32 v71, v71
    s_waitcnt lgkmcnt(0)
    v_smfmac_f32_32x32x32_bf16 v[164:179], v[124:127], v[56:63], v254
    s_add_u32 m0, s84, 0
    s_add_u32 s53, s85, 196608
    buffer_load_dwordx4 v17, s[28:31], s53 offen lds
    v_smfmac_f32_32x32x32_bf16 v[164:179], v[128:131], v[64:71], v254
    s_mov_b64 exec, s[92:93]
    ds_read_b128 v[124:127], v14 offset:25600
    ds_read_b128 v[128:131], v14 offset:26112
    s_mov_b64 exec, -1
    s_add_u32 m0, s84, 1024
    s_add_u32 s53, s85, 204800
    buffer_load_dwordx4 v17, s[28:31], s53 offen lds
    v_mfma_f32_32x32x16_bf16 v[56:71], v[180:183], v[120:123], v[24:39]
    ds_read_b128 v[180:183], v13 offset:26624
    v_mfma_f32_32x32x16_bf16 v[184:199], v[140:143], v[80:83], v[184:199]
    v_mfma_f32_32x32x16_bf16 v[200:215], v[144:147], v[80:83], v[200:215]
    s_setprio 0
    v_exp_f32 v40, v40
    s_setprio 2
    v_exp_f32 v41, v41
    v_exp_f32 v42, v42
    v_exp_f32 v43, v43
    v_exp_f32 v44, v44
    v_exp_f32 v45, v45
    v_exp_f32 v46, v46
    v_exp_f32 v47, v47
    v_exp_f32 v48, v48
    v_exp_f32 v49, v49
    v_exp_f32 v50, v50
    v_exp_f32 v51, v51
    v_exp_f32 v52, v52
    v_exp_f32 v53, v53
    v_exp_f32 v54, v54
    s_setprio 3
    v_exp_f32 v55, v55
    s_waitcnt lgkmcnt(0)
    v_smfmac_f32_32x32x32_bf16 v[104:119], v[124:127], v[40:47], v254
    buffer_load_dwordx4 v[156:159], v2, s[44:47], s86 offen offset:1024 sc1
    v_smfmac_f32_32x32x32_bf16 v[104:119], v[128:131], v[48:55], v254
    buffer_load_dwordx4 v[160:163], v2, s[44:47], s87 offen offset:1024 sc1
    v_mfma_f32_32x32x16_bf16 v[40:55], v[180:183], v[132:135], v[24:39]
    s_waitcnt vmcnt(6)
    ds_read_b64_tr_b16 v[96:97], v18 offset:2048
    ds_read_b64_tr_b16 v[98:99], v18 offset:3072
    ds_read_b64_tr_b16 v[100:101], v19 offset:2048
    ds_read_b64_tr_b16 v[102:103], v19 offset:3072
    v_mfma_f32_32x32x16_bf16 v[216:231], v[140:143], v[84:87], v[216:231]
    v_mfma_f32_32x32x16_bf16 v[232:247], v[144:147], v[84:87], v[232:247]
    s_setprio 0
    v_exp_f32 v56, v56
    s_setprio 2
    v_exp_f32 v57, v57
    v_exp_f32 v58, v58
    v_exp_f32 v59, v59
    v_exp_f32 v60, v60
    v_exp_f32 v61, v61
    v_exp_f32 v62, v62
    v_exp_f32 v63, v63
    v_exp_f32 v64, v64
    v_exp_f32 v65, v65
    v_exp_f32 v66, v66
    v_exp_f32 v67, v67
    v_exp_f32 v68, v68
    v_exp_f32 v69, v69
    v_exp_f32 v70, v70
    s_setprio 3
    v_exp_f32 v71, v71
    s_waitcnt lgkmcnt(0)
    v_smfmac_f32_32x32x32_bf16 v[164:179], v[124:127], v[56:63], v254
    s_add_u32 m0, s84, 2048
    s_add_u32 s53, s85, 212992
    buffer_load_dwordx4 v17, s[28:31], s53 offen lds
    v_smfmac_f32_32x32x32_bf16 v[164:179], v[128:131], v[64:71], v254
    s_mov_b64 exec, s[92:93]
    ds_read_b128 v[124:127], v14 offset:26624
    ds_read_b128 v[128:131], v14 offset:27136
    s_mov_b64 exec, -1
    s_add_u32 m0, s84, 3072
    s_add_u32 s53, s85, 221184
    buffer_load_dwordx4 v17, s[28:31], s53 offen lds
    v_mfma_f32_32x32x16_bf16 v[56:71], v[180:183], v[120:123], v[24:39]
    ds_read_b128 v[180:183], v13 offset:27648
    v_mfma_f32_32x32x16_bf16 v[184:199], v[96:99], v[88:91], v[184:199]
    v_mfma_f32_32x32x16_bf16 v[200:215], v[100:103], v[88:91], v[200:215]
    s_setprio 0
    v_exp_f32 v40, v40
    s_setprio 2
    v_exp_f32 v41, v41
    v_exp_f32 v42, v42
    v_exp_f32 v43, v43
    v_exp_f32 v44, v44
    v_exp_f32 v45, v45
    v_exp_f32 v46, v46
    v_exp_f32 v47, v47
    v_exp_f32 v48, v48
    v_exp_f32 v49, v49
    v_exp_f32 v50, v50
    v_exp_f32 v51, v51
    v_exp_f32 v52, v52
    v_exp_f32 v53, v53
    v_exp_f32 v54, v54
    s_setprio 3
    v_exp_f32 v55, v55
    s_waitcnt lgkmcnt(0)
    v_smfmac_f32_32x32x32_bf16 v[104:119], v[124:127], v[40:47], v254
    v_smfmac_f32_32x32x32_bf16 v[104:119], v[128:131], v[48:55], v254
    v_mfma_f32_32x32x16_bf16 v[40:55], v[180:183], v[132:135], v[24:39]
    s_waitcnt vmcnt(4)
    ds_read_b64_tr_b16 v[140:141], v18 offset:0
    ds_read_b64_tr_b16 v[142:143], v18 offset:1024
    ds_read_b64_tr_b16 v[144:145], v19 offset:0
    ds_read_b64_tr_b16 v[146:147], v19 offset:1024
    v_mfma_f32_32x32x16_bf16 v[216:231], v[96:99], v[92:95], v[216:231]
    v_mfma_f32_32x32x16_bf16 v[232:247], v[100:103], v[92:95], v[232:247]
    s_setprio 0
    v_exp_f32 v56, v56
    s_setprio 2
    v_exp_f32 v57, v57
    v_exp_f32 v58, v58
    v_exp_f32 v59, v59
    v_exp_f32 v60, v60
    v_exp_f32 v61, v61
    v_exp_f32 v62, v62
    v_exp_f32 v63, v63
    v_exp_f32 v64, v64
    v_exp_f32 v65, v65
    v_exp_f32 v66, v66
    v_exp_f32 v67, v67
    v_exp_f32 v68, v68
    v_exp_f32 v69, v69
    v_exp_f32 v70, v70
    s_setprio 3
    v_exp_f32 v71, v71
    s_waitcnt lgkmcnt(0)
    v_smfmac_f32_32x32x32_bf16 v[164:179], v[124:127], v[56:63], v254
    v_smfmac_f32_32x32x32_bf16 v[164:179], v[128:131], v[64:71], v254
    s_mov_b64 exec, s[92:93]
    ds_read_b128 v[124:127], v14 offset:27648
    ds_read_b128 v[128:131], v14 offset:28160
    s_mov_b64 exec, -1
    v_mfma_f32_32x32x16_bf16 v[56:71], v[180:183], v[120:123], v[24:39]
    ds_read_b128 v[180:183], v13 offset:28672
    v_mfma_f32_32x32x16_bf16 v[184:199], v[140:143], v[148:151], v[184:199]
    v_mfma_f32_32x32x16_bf16 v[200:215], v[144:147], v[148:151], v[200:215]
    s_setprio 0
    v_exp_f32 v40, v40
    s_setprio 2
    v_exp_f32 v41, v41
    v_exp_f32 v42, v42
    v_exp_f32 v43, v43
    v_exp_f32 v44, v44
    v_exp_f32 v45, v45
    v_exp_f32 v46, v46
    v_exp_f32 v47, v47
    v_exp_f32 v48, v48
    v_exp_f32 v49, v49
    v_exp_f32 v50, v50
    v_exp_f32 v51, v51
    v_exp_f32 v52, v52
    v_exp_f32 v53, v53
    v_exp_f32 v54, v54
    s_setprio 3
    v_exp_f32 v55, v55
    s_waitcnt lgkmcnt(0)
    v_smfmac_f32_32x32x32_bf16 v[104:119], v[124:127], v[40:47], v254
    v_smfmac_f32_32x32x32_bf16 v[104:119], v[128:131], v[48:55], v254
    v_mfma_f32_32x32x16_bf16 v[40:55], v[180:183], v[132:135], v[24:39]
    s_waitcnt vmcnt(0)
    ds_read_b64_tr_b16 v[96:97], v18 offset:2048
    ds_read_b64_tr_b16 v[98:99], v18 offset:3072
    ds_read_b64_tr_b16 v[100:101], v19 offset:2048
    ds_read_b64_tr_b16 v[102:103], v19 offset:3072
    v_mfma_f32_32x32x16_bf16 v[216:231], v[140:143], v[152:155], v[216:231]
    v_mfma_f32_32x32x16_bf16 v[232:247], v[144:147], v[152:155], v[232:247]
    s_setprio 0
    v_exp_f32 v56, v56
    s_setprio 2
    v_exp_f32 v57, v57
    v_exp_f32 v58, v58
    v_exp_f32 v59, v59
    v_exp_f32 v60, v60
    v_exp_f32 v61, v61
    v_exp_f32 v62, v62
    v_exp_f32 v63, v63
    v_exp_f32 v64, v64
    v_exp_f32 v65, v65
    v_exp_f32 v66, v66
    v_exp_f32 v67, v67
    v_exp_f32 v68, v68
    v_exp_f32 v69, v69
    v_exp_f32 v70, v70
    s_setprio 3
    v_exp_f32 v71, v71
    s_waitcnt lgkmcnt(0)
    v_smfmac_f32_32x32x32_bf16 v[164:179], v[124:127], v[56:63], v254
    v_smfmac_f32_32x32x32_bf16 v[164:179], v[128:131], v[64:71], v254
    s_mov_b64 exec, s[92:93]
    ds_read_b128 v[124:127], v14 offset:28672
    ds_read_b128 v[128:131], v14 offset:29184
    s_mov_b64 exec, -1
    v_mfma_f32_32x32x16_bf16 v[56:71], v[180:183], v[120:123], v[24:39]
    ds_read_b128 v[180:183], v13 offset:29696
    v_add_u32 v10, s62, v2
    v_add_u32 v11, s84, v2
    v_lshlrev_b32 v12, 2, v0
    v_add_u32 v12, 28672, v12
    s_lshl_b32 s55, s52, 16
    v_mfma_f32_32x32x16_bf16 v[216:231], v[96:99], v[160:163], v[216:231]
    v_mfma_f32_32x32x16_bf16 v[232:247], v[100:103], v[160:163], v[232:247]
    s_setprio 0
    v_exp_f32 v40, v40
    s_setprio 2
    v_exp_f32 v41, v41
    v_exp_f32 v42, v42
    v_exp_f32 v43, v43
    v_exp_f32 v44, v44
    v_exp_f32 v45, v45
    v_exp_f32 v46, v46
    v_exp_f32 v47, v47
    v_exp_f32 v48, v48
    v_exp_f32 v49, v49
    v_exp_f32 v50, v50
    v_exp_f32 v51, v51
    v_exp_f32 v52, v52
    v_exp_f32 v53, v53
    v_exp_f32 v54, v54
    s_setprio 3
    v_exp_f32 v55, v55
    s_waitcnt lgkmcnt(0)
    s_cmp_eq_u32 s63, 0
    s_cbranch_scc1 L_ab15
    s_barrier
L_ab15:
    v_smfmac_f32_32x32x32_bf16 v[104:119], v[124:127], v[40:47], v254
    v_smfmac_f32_32x32x32_bf16 v[104:119], v[128:131], v[48:55], v254
    v_mfma_f32_32x32x16_bf16 v[40:55], v[180:183], v[132:135], v[24:39]
    v_mfma_f32_32x32x16_bf16 v[184:199], v[96:99], v[156:159], v[184:199]
    s_cmp_eq_u32 s63, 1
    s_cbranch_scc1 L_ab16
    s_barrier
L_ab16:
    s_setprio 0
    v_exp_f32 v56, v56
    s_setprio 2
    v_exp_f32 v57, v57
    v_exp_f32 v58, v58
    v_exp_f32 v59, v59
    v_exp_f32 v60, v60
    v_exp_f32 v61, v61
    v_exp_f32 v62, v62
    v_exp_f32 v63, v63
    v_exp_f32 v64, v64
    v_exp_f32 v65, v65
    v_exp_f32 v66, v66
    v_exp_f32 v67, v67
    v_exp_f32 v68, v68
    v_exp_f32 v69, v69
    v_exp_f32 v70, v70
    s_setprio 3
    v_exp_f32 v71, v71
    s_waitcnt lgkmcnt(0)
    v_smfmac_f32_32x32x32_bf16 v[164:179], v[124:127], v[56:63], v254
    s_add_u32 m0, s91, 0
    s_add_u32 s53, s55, 0
    buffer_load_dwordx4 v17, s[40:43], s53 offen lds
    v_smfmac_f32_32x32x32_bf16 v[164:179], v[128:131], v[64:71], v254
    s_mov_b64 exec, s[92:93]
    ds_read_b128 v[124:127], v14 offset:29696
    ds_read_b128 v[128:131], v14 offset:30208
    s_mov_b64 exec, -1
    s_add_u32 m0, s91, 1024
    s_add_u32 s53, s55, 8192
    buffer_load_dwordx4 v17, s[40:43], s53 offen lds
    v_mfma_f32_32x32x16_bf16 v[56:71], v[180:183], v[120:123], v[24:39]
    ds_read_b128 v[180:183], v13 offset:30720
    v_mfma_f32_32x32x16_bf16 v[200:215], v[100:103], v[156:159], v[200:215]
    s_setprio 0
    v_exp_f32 v40, v40
    s_setprio 2
    v_exp_f32 v41, v41
    v_exp_f32 v42, v42
    v_exp_f32 v43, v43
    v_exp_f32 v44, v44
    v_exp_f32 v45, v45
    v_exp_f32 v46, v46
    v_exp_f32 v47, v47
    v_exp_f32 v48, v48
    v_exp_f32 v49, v49
    v_exp_f32 v50, v50
    v_exp_f32 v51, v51
    v_exp_f32 v52, v52
    v_exp_f32 v53, v53
    v_exp_f32 v54, v54
    s_setprio 3
    v_exp_f32 v55, v55
    s_waitcnt lgkmcnt(0)
    v_smfmac_f32_32x32x32_bf16 v[104:119], v[124:127], v[40:47], v254
    s_add_u32 m0, s91, 2048
    s_add_u32 s53, s55, 16384
    buffer_load_dwordx4 v17, s[40:43], s53 offen lds
    v_smfmac_f32_32x32x32_bf16 v[104:119], v[128:131], v[48:55], v254
    s_add_u32 m0, s91, 3072
    s_add_u32 s53, s55, 24576
    buffer_load_dwordx4 v17, s[40:43], s53 offen lds
    v_mfma_f32_32x32x16_bf16 v[40:55], v[180:183], v[132:135], v[24:39]
    ds_write_b128 v10, v[216:219] offset:0
    ds_write_b128 v10, v[220:223] offset:1024
    s_setprio 0
    v_exp_f32 v56, v56
    s_setprio 2
    v_exp_f32 v57, v57
    v_exp_f32 v58, v58
    v_exp_f32 v59, v59
    v_exp_f32 v60, v60
    v_exp_f32 v61, v61
    v_exp_f32 v62, v62
    v_exp_f32 v63, v63
    v_exp_f32 v64, v64
    v_exp_f32 v65, v65
    v_exp_f32 v66, v66
    v_exp_f32 v67, v67
    v_exp_f32 v68, v68
    v_exp_f32 v69, v69
    v_exp_f32 v70, v70
    s_setprio 3
    v_exp_f32 v71, v71
    s_waitcnt lgkmcnt(0)
    v_smfmac_f32_32x32x32_bf16 v[164:179], v[124:127], v[56:63], v254
    s_add_u32 m0, s91, 4096
    s_add_u32 s53, s55, 32768
    buffer_load_dwordx4 v17, s[40:43], s53 offen lds
    v_smfmac_f32_32x32x32_bf16 v[164:179], v[128:131], v[64:71], v254
    s_mov_b64 exec, s[92:93]
    ds_read_b128 v[124:127], v14 offset:30720
    ds_read_b128 v[128:131], v14 offset:31232
    s_mov_b64 exec, -1
    s_add_u32 m0, s91, 5120
    s_add_u32 s53, s55, 40960
    buffer_load_dwordx4 v17, s[40:43], s53 offen lds
    v_mfma_f32_32x32x16_bf16 v[56:71], v[180:183], v[120:123], v[24:39]
    ds_read_b128 v[180:183], v13 offset:31744
    ds_write_b128 v10, v[224:227] offset:2048
    s_setprio 0
    v_exp_f32 v40, v40
    s_setprio 2
    v_exp_f32 v41, v41
    v_exp_f32 v42, v42
    v_exp_f32 v43, v43
    v_exp_f32 v44, v44
    v_exp_f32 v45, v45
    v_exp_f32 v46, v46
    v_exp_f32 v47, v47
    v_exp_f32 v48, v48
    v_exp_f32 v49, v49
    v_exp_f32 v50, v50
    v_exp_f32 v51, v51
    v_exp_f32 v52, v52
    v_exp_f32 v53, v53
    v_exp_f32 v54, v54
    s_setprio 3
    v_exp_f32 v55, v55
    s_waitcnt lgkmcnt(0)
    v_smfmac_f32_32x32x32_bf16 v[104:119], v[124:127], v[40:47], v254
    s_add_u32 m0, s91, 6144
    s_add_u32 s53, s55, 49152
    buffer_load_dwordx4 v17, s[40:43], s53 offen lds
    v_smfmac_f32_32x32x32_bf16 v[104:119], v[128:131], v[48:55], v254
    s_add_u32 m0, s91, 7168
    s_add_u32 s53, s55, 57344
    buffer_load_dwordx4 v17, s[40:43], s53 offen lds
    v_mfma_f32_32x32x16_bf16 v[40:55], v[180:183], v[132:135], v[24:39]
    ds_write_b128 v10, v[228:231] offset:3072
    s_setprio 0
    v_exp_f32 v56, v56
    s_setprio 2
    v_exp_f32 v57, v57
    v_exp_f32 v58, v58
    v_exp_f32 v59, v59
    v_exp_f32 v60, v60
    v_exp_f32 v61, v61
    v_exp_f32 v62, v62
    v_exp_f32 v63, v63
    v_exp_f32 v64, v64
    v_exp_f32 v65, v65
    v_exp_f32 v66, v66
    v_exp_f32 v67, v67
    v_exp_f32 v68, v68
    v_exp_f32 v69, v69
    v_exp_f32 v70, v70
    s_setprio 3
    v_exp_f32 v71, v71
    s_waitcnt lgkmcnt(0)
    v_smfmac_f32_32x32x32_bf16 v[164:179], v[124:127], v[56:63], v254
    v_smfmac_f32_32x32x32_bf16 v[164:179], v[128:131], v[64:71], v254
    s_mov_b64 exec, s[92:93]
    ds_read_b128 v[124:127], v14 offset:31744
    ds_read_b128 v[128:131], v14 offset:32256
    s_mov_b64 exec, -1
    v_mfma_f32_32x32x16_bf16 v[56:71], v[180:183], v[120:123], v[24:39]
    ds_write_b128 v10, v[232:235] offset:4096
    ds_write_b128 v10, v[236:239] offset:5120
    s_setprio 0
    v_exp_f32 v40, v40
    s_setprio 2
    v_exp_f32 v41, v41
    v_exp_f32 v42, v42
    v_exp_f32 v43, v43
    v_exp_f32 v44, v44
    v_exp_f32 v45, v45
    v_exp_f32 v46, v46
    v_exp_f32 v47, v47
    v_exp_f32 v48, v48
    v_exp_f32 v49, v49
    v_exp_f32 v50, v50
    v_exp_f32 v51, v51
    v_exp_f32 v52, v52
    v_exp_f32 v53, v53
    v_exp_f32 v54, v54
    s_setprio 3
    v_exp_f32 v55, v55
    s_waitcnt lgkmcnt(0)
    v_smfmac_f32_32x32x32_bf16 v[104:119], v[124:127], v[40:47], v254
    v_smfmac_f32_32x32x32_bf16 v[104:119], v[128:131], v[48:55], v254
    ds_write_b128 v11, v[240:243] offset:0
    s_setprio 0
    v_exp_f32 v56, v56
    s_setprio 2
    v_exp_f32 v57, v57
    v_exp_f32 v58, v58
    v_exp_f32 v59, v59
    v_exp_f32 v60, v60
    v_exp_f32 v61, v61
    v_exp_f32 v62, v62
    v_exp_f32 v63, v63
    v_exp_f32 v64, v64
    v_exp_f32 v65, v65
    v_exp_f32 v66, v66
    v_exp_f32 v67, v67
    v_exp_f32 v68, v68
    v_exp_f32 v69, v69
    v_exp_f32 v70, v70
    s_setprio 3
    v_exp_f32 v71, v71
    s_waitcnt lgkmcnt(0)
    v_smfmac_f32_32x32x32_bf16 v[164:179], v[124:127], v[56:63], v254
    v_smfmac_f32_32x32x32_bf16 v[164:179], v[128:131], v[64:71], v254
    ds_write_b128 v11, v[104:107] offset:2048
    ds_write_b128 v11, v[108:111] offset:3072
    ds_write_b32 v12, v112
    ds_write_b128 v11, v[244:247] offset:1024
    v_sub_f32 v16, 1.0, v16
    v_cvt_pk_bf16_f32 v16, v16, v16
    v_lshlrev_b32 v16, 16, v16
    v_mov_b32 v17, v16
    s_cmp_eq_u32 s63, 0
    s_movk_i32 s53, 6144
    s_cselect_b32 s53, s53, -6144
    v_add_u32 v10, s53, v10
    v_xor_b32 v11, 16384, v11
    v_xor_b32 v12, 1024, v12
    s_lshl_b32 s53, s3, 15
    s_sub_u32 s53, s53, s84
    v_add_u32 v18, s53, v18
    v_add_u32 v19, s53, v19
    s_add_u32 s87, s98, 4096
    s_waitcnt vmcnt(0) lgkmcnt(0)
    s_barrier
    ds_read_b128 v[72:75], v11 offset:2048
    ds_read_b128 v[76:79], v11 offset:3072
    ds_read_b32 v5, v12
    s_waitcnt lgkmcnt(0)
    v_pk_add_f32 v[164:165], v[164:165], v[72:73]
    v_pk_add_f32 v[166:167], v[166:167], v[74:75]
    v_pk_add_f32 v[168:169], v[168:169], v[76:77]
    v_pk_add_f32 v[170:171], v[170:171], v[78:79]
    v_add_f32 v172, v172, v5
    v_max3_f32 v3, |v164|, |v165|, |v166|
    v_max3_f32 v4, |v167|, |v168|, |v169|
    v_max3_f32 v3, |v170|, |v171|, v3
    v_max_f32 v3, v3, v4
    v_cmp_gt_f32 vcc, 0x53800000, v172
    s_mov_b32 s55, 0x7f800000
    v_cmp_gt_f32 s[26:27], s55, v3
    s_nop 0
    s_and_b64 s[26:27], vcc, s[26:27]
    v_cmp_lt_f32 vcc, 0x2b800000, v172
    s_nop 0
    s_and_b64 vcc, vcc, s[26:27]
    s_cmp_eq_u64 vcc, -1
    s_cbranch_scc1 L_afin
    v_mov_b32 v7, 0xff800000
    s_lshl_b32 s53, s80, 16
    s_add_u32 s54, s53, 2097152
    s_mov_b32 s56, 64
    s_nop 1
L_slow1:
    buffer_load_dwordx4 v[180:183], v2, s[44:47], s54 offen sc1
    s_add_u32 s54, s54, 1024
    s_waitcnt vmcnt(0)
    v_mfma_f32_32x32x16_bf16 v[40:55], v[180:183], v[120:123], 0
    s_nop 11
    v_max3_f32 v3, v40, v41, v42
    v_max3_f32 v4, v43, v44, v45
    v_max3_f32 v5, v46, v47, v48
    v_max3_f32 v6, v49, v50, v51
    v_max3_f32 v3, v3, v52, v53
    v_max3_f32 v4, v4, v54, v55
    v_max3_f32 v3, v3, v4, v5
    v_max3_f32 v7, v3, v6, v7
    s_sub_u32 s56, s56, 1
    s_cmp_lg_u32 s56, 0
    s_nop 2
    s_cbranch_scc1 L_slow1
    v_mov_b32 v4, v7
    s_nop 1
    v_permlane32_swap_b32 v7, v4
    v_max_f32 v7, v7, v4
    v_sub_f32 v24, 0, v7
    v_sub_f32 v25, 0, v7
    v_sub_f32 v26, 0, v7
    v_sub_f32 v27, 0, v7
    v_sub_f32 v28, 0, v7
    v_sub_f32 v29, 0, v7
    v_sub_f32 v30, 0, v7
    v_sub_f32 v31, 0, v7
    v_sub_f32 v32, 0, v7
    v_sub_f32 v33, 0, v7
    v_sub_f32 v34, 0, v7
    v_sub_f32 v35, 0, v7
    v_sub_f32 v36, 0, v7
    v_sub_f32 v37, 0, v7
    v_sub_f32 v38, 0, v7
    v_sub_f32 v39, 0, v7
    v_mov_b32 v164, 0
    v_mov_b32 v165, 0
    v_mov_b32 v166, 0
    v_mov_b32 v167, 0
    v_mov_b32 v168, 0
    v_mov_b32 v169, 0
    v_mov_b32 v170, 0
    v_mov_b32 v171, 0
    v_mov_b32 v172, 0
    v_mov_b32 v173, 0
    v_mov_b32 v174, 0
    v_mov_b32 v175, 0
    v_mov_b32 v176, 0
    v_mov_b32 v177, 0
    v_mov_b32 v178, 0
    v_mov_b32 v179, 0
    v_and_b32 v7, 0x1ff, v14
    s_add_u32 s54, s53, 2097152
    s_add_u32 s55, s53, 4194304
    s_mov_b32 s56, 64
    s_nop 1
L_slow2:
    buffer_load_dwordx4 v[180:183], v2, s[44:47], s54 offen sc1
    s_mov_b64 exec, s[92:93]
    buffer_load_dwordx4 v[124:127], v7, s[44:47], s55 offen sc1
    buffer_load_dwordx4 v[128:131], v7, s[44:47], s55 offen offset:512 sc1
    s_mov_b64 exec, -1
    s_add_u32 s54, s54, 1024
    s_add_u32 s55, s55, 1024
    s_waitcnt vmcnt(0)
    v_mfma_f32_32x32x16_bf16 v[40:55], v[180:183], v[120:123], v[24:39]
    s_nop 11
    v_exp_f32 v40, v40
    v_exp_f32 v41, v41
    v_exp_f32 v42, v42
    v_exp_f32 v43, v43
    v_exp_f32 v44, v44
    v_exp_f32 v45, v45
    v_exp_f32 v46, v46
    v_exp_f32 v47, v47
    v_exp_f32 v48, v48
    v_exp_f32 v49, v49
    v_exp_f32 v50, v50
    v_exp_f32 v51, v51
    v_exp_f32 v52, v52
    v_exp_f32 v53, v53
    v_exp_f32 v54, v54
    v_exp_f32 v55, v55
    v_smfmac_f32_32x32x32_bf16 v[164:179], v[124:127], v[40:47], v254
    s_nop 0
    v_smfmac_f32_32x32x32_bf16 v[164:179], v[128:131], v[48:55], v254
    s_sub_u32 s56, s56, 1
    s_cmp_lg_u32 s56, 0
    s_nop 9
    s_cbranch_scc1 L_slow2
L_afin:
    v_rcp_f32 v3, v172
    s_nop 0
    v_mul_f32 v4, v3, v15
    v_pk_mul_f32 v[164:165], v[164:165], v[4:5] op_sel_hi:[1,0]
    v_pk_mul_f32 v[166:167], v[166:167], v[4:5] op_sel_hi:[1,0]
    v_pk_mul_f32 v[168:169], v[168:169], v[4:5] op_sel_hi:[1,0]
    v_pk_mul_f32 v[170:171], v[170:171], v[4:5] op_sel_hi:[1,0]
    v_cvt_pk_bf16_f32 v180, v164, v165
    v_cvt_pk_bf16_f32 v181, v166, v167
    v_cvt_pk_bf16_f32 v182, v168, v169
    v_cvt_pk_bf16_f32 v183, v170, v171
    v_min_u32 v180, -2, v180
    v_min_u32 v181, -2, v181
    v_min_u32 v182, -2, v182
    v_min_u32 v183, -2, v183
    buffer_store_dwordx4 v[180:183], v2, s[44:47], s97 offen sc1
    ds_read_b128 v[216:219], v10 offset:0
    ds_read_b128 v[220:223], v10 offset:1024
    ds_read_b128 v[224:227], v10 offset:2048
    ds_read_b128 v[228:231], v10 offset:3072
    ds_read_b128 v[232:235], v10 offset:4096
    ds_read_b128 v[236:239], v10 offset:5120
    ds_read_b128 v[240:243], v11 offset:0
    ds_read_b128 v[244:247], v11 offset:1024
    ds_read_b64_tr_b16 v[24:25], v18 offset:0
    ds_read_b64_tr_b16 v[26:27], v18 offset:1024
    ds_read_b64_tr_b16 v[28:29], v19 offset:0
    ds_read_b64_tr_b16 v[30:31], v19 offset:1024
    v_and_b32 v5, 31, v1
    v_lshlrev_b32 v5, 10, v5
    v_lshrrev_b32 v6, 5, v1
    v_lshl_add_u32 v5, v6, 4, v5
    v_xor_b32 v7, 32768, v10
    v_xor_b32 v8, 65536, v10
    v_xor_b32 v9, 98304, v10
    s_waitcnt lgkmcnt(4)
    ds_read_b64_tr_b16 v[32:33], v18 offset:2048
    ds_read_b64_tr_b16 v[34:35], v18 offset:3072
    ds_read_b64_tr_b16 v[36:37], v19 offset:2048
    ds_read_b64_tr_b16 v[38:39], v19 offset:3072
    v_pk_add_f32 v[184:185], v[184:185], v[216:217]
    v_pk_mul_f32 v[184:185], v[184:185], v[16:17]
    v_pk_add_f32 v[186:187], v[186:187], v[218:219]
    v_pk_mul_f32 v[186:187], v[186:187], v[16:17]
    ds_read_b64_tr_b16 v[40:41], v18 offset:4096
    ds_read_b64_tr_b16 v[42:43], v18 offset:5120
    ds_read_b64_tr_b16 v[44:45], v19 offset:4096
    ds_read_b64_tr_b16 v[46:47], v19 offset:5120
    v_pk_add_f32 v[188:189], v[188:189], v[220:221]
    v_pk_mul_f32 v[188:189], v[188:189], v[16:17]
    v_pk_add_f32 v[190:191], v[190:191], v[222:223]
    v_pk_mul_f32 v[190:191], v[190:191], v[16:17]
    s_waitcnt lgkmcnt(4)
    ds_read_b64_tr_b16 v[48:49], v18 offset:6144
    ds_read_b64_tr_b16 v[50:51], v18 offset:7168
    ds_read_b64_tr_b16 v[52:53], v19 offset:6144
    ds_read_b64_tr_b16 v[54:55], v19 offset:7168
    v_pk_add_f32 v[192:193], v[192:193], v[224:225]
    v_pk_mul_f32 v[192:193], v[192:193], v[16:17]
    v_pk_add_f32 v[194:195], v[194:195], v[226:227]
    v_pk_mul_f32 v[194:195], v[194:195], v[16:17]
    ds_read_b64_tr_b16 v[56:57], v18 offset:8192
    ds_read_b64_tr_b16 v[58:59], v18 offset:9216
    ds_read_b64_tr_b16 v[60:61], v19 offset:8192
    ds_read_b64_tr_b16 v[62:63], v19 offset:9216
    v_pk_add_f32 v[196:197], v[196:197], v[228:229]
    v_pk_mul_f32 v[196:197], v[196:197], v[16:17]
    v_pk_add_f32 v[198:199], v[198:199], v[230:231]
    v_pk_mul_f32 v[198:199], v[198:199], v[16:17]
    s_waitcnt lgkmcnt(4)
    ds_read_b64_tr_b16 v[64:65], v18 offset:10240
    ds_read_b64_tr_b16 v[66:67], v18 offset:11264
    ds_read_b64_tr_b16 v[68:69], v19 offset:10240
    ds_read_b64_tr_b16 v[70:71], v19 offset:11264
    v_pk_add_f32 v[200:201], v[200:201], v[232:233]
    v_pk_mul_f32 v[200:201], v[200:201], v[16:17]
    v_pk_add_f32 v[202:203], v[202:203], v[234:235]
    v_pk_mul_f32 v[202:203], v[202:203], v[16:17]
    ds_read_b64_tr_b16 v[72:73], v18 offset:12288
    ds_read_b64_tr_b16 v[74:75], v18 offset:13312
    ds_read_b64_tr_b16 v[76:77], v19 offset:12288
    ds_read_b64_tr_b16 v[78:79], v19 offset:13312
    v_pk_add_f32 v[204:205], v[204:205], v[236:237]
    v_pk_mul_f32 v[204:205], v[204:205], v[16:17]
    v_pk_add_f32 v[206:207], v[206:207], v[238:239]
    v_pk_mul_f32 v[206:207], v[206:207], v[16:17]
    s_waitcnt lgkmcnt(4)
    ds_read_b64_tr_b16 v[80:81], v18 offset:14336
    ds_read_b64_tr_b16 v[82:83], v18 offset:15360
    ds_read_b64_tr_b16 v[84:85], v19 offset:14336
    ds_read_b64_tr_b16 v[86:87], v19 offset:15360
    v_pk_add_f32 v[208:209], v[208:209], v[240:241]
    v_pk_mul_f32 v[208:209], v[208:209], v[16:17]
    v_pk_add_f32 v[210:211], v[210:211], v[242:243]
    v_pk_mul_f32 v[210:211], v[210:211], v[16:17]
    v_pk_add_f32 v[212:213], v[212:213], v[244:245]
    v_pk_mul_f32 v[212:213], v[212:213], v[16:17]
    v_pk_add_f32 v[214:215], v[214:215], v[246:247]
    v_pk_mul_f32 v[214:215], v[214:215], v[16:17]
    s_mov_b32 s56, 0
    s_mov_b32 s54, 0xff
    s_mov_b32 s55, 0
    s_waitcnt vmcnt(0)
    buffer_load_dwordx4 v[88:91], v2, s[44:47], s98 offen offset:0 sc1
    buffer_load_dwordx4 v[92:95], v2, s[44:47], s98 offen offset:1024 sc1
    buffer_load_dwordx4 v[96:99], v2, s[44:47], s98 offen offset:2048 sc1
    buffer_load_dwordx4 v[100:103], v2, s[44:47], s98 offen offset:3072 sc1
    buffer_load_dwordx4 v[104:107], v2, s[44:47], s87 offen offset:0 sc1
    buffer_load_dwordx4 v[108:111], v2, s[44:47], s87 offen offset:1024 sc1
    buffer_load_dwordx4 v[112:115], v2, s[44:47], s87 offen offset:2048 sc1
    buffer_load_dwordx4 v[116:119], v2, s[44:47], s87 offen offset:3072 sc1
    s_waitcnt lgkmcnt(0)
    s_nop 1
L_opass:
    s_bitcmp0_b32 s54, 0
    s_cbranch_scc1 L_ov0
    s_waitcnt vmcnt(7)
    v_max3_u32 v3, v88, v89, v90
    v_max_u32 v3, v3, v91
    v_cmp_eq_u32 vcc, -1, v3
    s_nop 0
    s_cmp_lg_u64 vcc, 0
    s_cbranch_scc1 L_on0
    s_bitset0_b32 s54, 0
L_ov0:
    s_cmp_lg_u32 s55, 0
    s_cbranch_scc1 L_on0
    v_mfma_f32_32x32x16_bf16 v[184:199], v[24:27], v[88:91], v[184:199]
    v_mfma_f32_32x32x16_bf16 v[200:215], v[28:31], v[88:91], v[200:215]
    s_mov_b32 s55, 1
L_on0:
    s_bitcmp0_b32 s54, 1
    s_cbranch_scc1 L_ov1
    s_waitcnt vmcnt(6)
    v_max3_u32 v3, v92, v93, v94
    v_max_u32 v3, v3, v95
    v_cmp_eq_u32 vcc, -1, v3
    s_nop 0
    s_cmp_lg_u64 vcc, 0
    s_cbranch_scc1 L_on1
    s_bitset0_b32 s54, 1
L_ov1:
    s_cmp_lg_u32 s55, 1
    s_cbranch_scc1 L_on1
    v_mfma_f32_32x32x16_bf16 v[184:199], v[32:35], v[92:95], v[184:199]
    v_mfma_f32_32x32x16_bf16 v[200:215], v[36:39], v[92:95], v[200:215]
    s_mov_b32 s55, 2
L_on1:
    s_bitcmp0_b32 s54, 2
    s_cbranch_scc1 L_ov2
    s_waitcnt vmcnt(5)
    v_max3_u32 v3, v96, v97, v98
    v_max_u32 v3, v3, v99
    v_cmp_eq_u32 vcc, -1, v3
    s_nop 0
    s_cmp_lg_u64 vcc, 0
    s_cbranch_scc1 L_on2
    s_bitset0_b32 s54, 2
L_ov2:
    s_cmp_lg_u32 s55, 2
    s_cbranch_scc1 L_on2
    v_mfma_f32_32x32x16_bf16 v[184:199], v[40:43], v[96:99], v[184:199]
    v_mfma_f32_32x32x16_bf16 v[200:215], v[44:47], v[96:99], v[200:215]
    s_mov_b32 s55, 3
L_on2:
    s_bitcmp0_b32 s54, 3
    s_cbranch_scc1 L_ov3
    s_waitcnt vmcnt(4)
    v_max3_u32 v3, v100, v101, v102
    v_max_u32 v3, v3, v103
    v_cmp_eq_u32 vcc, -1, v3
    s_nop 0
    s_cmp_lg_u64 vcc, 0
    s_cbranch_scc1 L_on3
    s_bitset0_b32 s54, 3
L_ov3:
    s_cmp_lg_u32 s55, 3
    s_cbranch_scc1 L_on3
    v_mfma_f32_32x32x16_bf16 v[184:199], v[48:51], v[100:103], v[184:199]
    v_mfma_f32_32x32x16_bf16 v[200:215], v[52:55], v[100:103], v[200:215]
    s_mov_b32 s55, 4
L_on3:
    s_bitcmp0_b32 s54, 4
    s_cbranch_scc1 L_ov4
    s_waitcnt vmcnt(3)
    v_max3_u32 v3, v104, v105, v106
    v_max_u32 v3, v3, v107
    v_cmp_eq_u32 vcc, -1, v3
    s_nop 0
    s_cmp_lg_u64 vcc, 0
    s_cbranch_scc1 L_on4
    s_bitset0_b32 s54, 4
L_ov4:
    s_cmp_lg_u32 s55, 4
    s_cbranch_scc1 L_on4
    v_mfma_f32_32x32x16_bf16 v[184:199], v[56:59], v[104:107], v[184:199]
    v_mfma_f32_32x32x16_bf16 v[200:215], v[60:63], v[104:107], v[200:215]
    s_mov_b32 s55, 5
L_on4:
    s_bitcmp0_b32 s54, 5
    s_cbranch_scc1 L_ov5
    s_waitcnt vmcnt(2)
    v_max3_u32 v3, v108, v109, v110
    v_max_u32 v3, v3, v111
    v_cmp_eq_u32 vcc, -1, v3
    s_nop 0
    s_cmp_lg_u64 vcc, 0
    s_cbranch_scc1 L_on5
    s_bitset0_b32 s54, 5
L_ov5:
    s_cmp_lg_u32 s55, 5
    s_cbranch_scc1 L_on5
    v_mfma_f32_32x32x16_bf16 v[184:199], v[64:67], v[108:111], v[184:199]
    v_mfma_f32_32x32x16_bf16 v[200:215], v[68:71], v[108:111], v[200:215]
    s_mov_b32 s55, 6
L_on5:
    s_bitcmp0_b32 s54, 6
    s_cbranch_scc1 L_ov6
    s_waitcnt vmcnt(1)
    v_max3_u32 v3, v112, v113, v114
    v_max_u32 v3, v3, v115
    v_cmp_eq_u32 vcc, -1, v3
    s_nop 0
    s_cmp_lg_u64 vcc, 0
    s_cbranch_scc1 L_on6
    s_bitset0_b32 s54, 6
L_ov6:
    s_cmp_lg_u32 s55, 6
    s_cbranch_scc1 L_on6
    v_mfma_f32_32x32x16_bf16 v[184:199], v[72:75], v[112:115], v[184:199]
    v_mfma_f32_32x32x16_bf16 v[200:215], v[76:79], v[112:115], v[200:215]
    s_mov_b32 s55, 7
L_on6:
    s_bitcmp0_b32 s54, 7
    s_cbranch_scc1 L_ov7
    s_waitcnt vmcnt(0)
    v_max3_u32 v3, v116, v117, v118
    v_max_u32 v3, v3, v119
    v_cmp_eq_u32 vcc, -1, v3
    s_nop 0
    s_cmp_lg_u64 vcc, 0
    s_cbranch_scc1 L_on7
    s_bitset0_b32 s54, 7
L_ov7:
    s_cmp_lg_u32 s55, 7
    s_cbranch_scc1 L_on7
    v_mfma_f32_32x32x16_bf16 v[184:199], v[80:83], v[116:119], v[184:199]
    v_mfma_f32_32x32x16_bf16 v[200:215], v[84:87], v[116:119], v[200:215]
    s_mov_b32 s55, 8
L_on7:
    s_cmp_lg_u32 s54, 0
    s_cbranch_scc1 L_oretry
L_odone:
    s_nop 7
    ds_write_b128 v10, v[192:195] offset:0
    ds_write_b128 v10, v[196:199] offset:1024
    ds_write_b128 v10, v[200:203] offset:2048
    ds_write_b128 v10, v[204:207] offset:3072
    ds_write_b128 v10, v[208:211] offset:4096
    ds_write_b128 v10, v[212:215] offset:5120
    s_waitcnt lgkmcnt(0)
    s_barrier
    ds_read_b128 v[96:99], v7 offset:0
    ds_read_b128 v[100:103], v7 offset:1024
    ds_read_b128 v[104:107], v8 offset:2048
    ds_read_b128 v[108:111], v8 offset:3072
    ds_read_b128 v[112:115], v9 offset:4096
    ds_read_b128 v[116:119], v9 offset:5120
    s_waitcnt lgkmcnt(4)
    v_pk_add_f32 v[184:185], v[184:185], v[96:97]
    v_pk_add_f32 v[186:187], v[186:187], v[98:99]
    v_pk_add_f32 v[188:189], v[188:189], v[100:101]
    v_pk_add_f32 v[190:191], v[190:191], v[102:103]
    s_waitcnt lgkmcnt(0)
    v_pk_add_f32 v[104:105], v[104:105], v[112:113]
    v_pk_add_f32 v[106:107], v[106:107], v[114:115]
    v_pk_add_f32 v[108:109], v[108:109], v[116:117]
    v_pk_add_f32 v[110:111], v[110:111], v[118:119]
    v_pk_add_f32 v[184:185], v[184:185], v[104:105]
    v_pk_add_f32 v[186:187], v[186:187], v[106:107]
    v_pk_add_f32 v[188:189], v[188:189], v[108:109]
    v_pk_add_f32 v[190:191], v[190:191], v[110:111]
    v_cvt_pk_bf16_f32 v24, v184, v185
    v_cvt_pk_bf16_f32 v25, v186, v187
    v_cvt_pk_bf16_f32 v26, v188, v189
    v_cvt_pk_bf16_f32 v27, v190, v191
    s_nop 0
    v_permlane32_swap_b32 v24, v26
    v_permlane32_swap_b32 v25, v27
    buffer_store_dwordx4 v[24:27], v5, s[48:51], s96 offen
    s_endpgm
L_oretry:
    s_add_u32 s56, s56, 1
    s_cmp_ge_u32 s56, 40000
    s_cbranch_scc1 L_odone
    s_sleep 3
    s_bitcmp0_b32 s54, 0
    s_cbranch_scc1 L_oq0
    buffer_load_dwordx4 v[88:91], v2, s[44:47], s98 offen offset:0 sc1
L_oq0:
    s_bitcmp0_b32 s54, 1
    s_cbranch_scc1 L_oq1
    buffer_load_dwordx4 v[92:95], v2, s[44:47], s98 offen offset:1024 sc1
L_oq1:
    s_bitcmp0_b32 s54, 2
    s_cbranch_scc1 L_oq2
    buffer_load_dwordx4 v[96:99], v2, s[44:47], s98 offen offset:2048 sc1
L_oq2:
    s_bitcmp0_b32 s54, 3
    s_cbranch_scc1 L_oq3
    buffer_load_dwordx4 v[100:103], v2, s[44:47], s98 offen offset:3072 sc1
L_oq3:
    s_bitcmp0_b32 s54, 4
    s_cbranch_scc1 L_oq4
    buffer_load_dwordx4 v[104:107], v2, s[44:47], s87 offen offset:0 sc1
L_oq4:
    s_bitcmp0_b32 s54, 5
    s_cbranch_scc1 L_oq5
    buffer_load_dwordx4 v[108:111], v2, s[44:47], s87 offen offset:1024 sc1
L_oq5:
    s_bitcmp0_b32 s54, 6
    s_cbranch_scc1 L_oq6
    buffer_load_dwordx4 v[112:115], v2, s[44:47], s87 offen offset:2048 sc1
L_oq6:
    s_bitcmp0_b32 s54, 7
    s_cbranch_scc1 L_oq7
    buffer_load_dwordx4 v[116:119], v2, s[44:47], s87 offen offset:3072 sc1
L_oq7:
    s_waitcnt vmcnt(0)
    s_branch L_opass
L_end:
    s_endpgm
.section .rodata,"a"
.p2align 6
.amdhsa_kernel gated_mix__mha_block__glu_gated_geglu__prompt_kernel
  .amdhsa_next_free_vgpr 256
  .amdhsa_next_free_sgpr 102
  .amdhsa_accum_offset 256
  .amdhsa_group_segment_fixed_size 0
  .amdhsa_kernarg_size 88
  .amdhsa_user_sgpr_count 2
  .amdhsa_user_sgpr_kernarg_segment_ptr 1
  .amdhsa_system_sgpr_workgroup_id_x 1
.end_amdhsa_kernel
```
